```python
import torch

def _softmax(x, axis=-1):
    return torch.softmax(x, dim=axis)

def _gelu(x):
    return torch.nn.functional.gelu(x, approximate='tanh')

def _silu(x):
    return torch.nn.functional.silu(x)

def _sigmoid(x):
    return torch.sigmoid(x)

def _layernorm(x, axis=-1, eps=1e-05):
    m = x.mean(dim=axis, keepdim=True)
    v = x.var(dim=axis, keepdim=True, unbiased=False)
    return (x - m) / torch.sqrt(v + eps)

def _scatter_add(tgt, idx, src, axis=0):
    return tgt.clone().index_add_(axis, idx, src)

def _segment_sum(src, seg, n):
    out = torch.zeros((n,) + src.shape[1:], dtype=src.dtype)
    return out.index_add_(0, seg, src)

def _pad(x, pw):
    flat = tuple((v for pair in reversed(pw) for v in pair))
    return torch.nn.functional.pad(x, flat)
kernel_name = 'recurrent_scan__spectral_gfnet__mixer_gmlp__prompt'

def setup_inputs():

    _w = lambda a: (lambda t: t.to(torch.bfloat16) if t.is_floating_point() else t)(torch.as_tensor(a))

    def _A_setup():
        B, S, D = (1, 2048, 512)
        Df = D // 2 + 1
        return {'x': _w((lambda *s: torch.randn(*s, dtype=torch.bfloat16) * 0.05)(B, S, D)), 'w_r': _w((lambda *s: torch.randn(*s, dtype=torch.bfloat16) * 0.2)(S, Df) * 0.02), 'w_i': _w((lambda *s: torch.randn(*s, dtype=torch.bfloat16) * 0.2)(S, Df) * 0.02)}
    _A_in = _A_setup()

    def _B_setup():
        B, S, D, F = (1, 2048, 512, 1376)
        Fh = F // 2
        return {'x': _w((lambda *s: torch.randn(*s, dtype=torch.bfloat16) * 0.05)(B, S, D)), 'w_in': _w((lambda *s: torch.randn(*s, dtype=torch.bfloat16) * 0.4)(D, 2 * Fh)), 'w_sp': _w(0.01 * (lambda *s: torch.randn(*s, dtype=torch.bfloat16) * 0.4)(S, S)), 'b_sp': _w(1.0 + 0.01 * (lambda *s: torch.randn(*s, dtype=torch.bfloat16) * 0.1)(S)), 'w_out': _w((lambda *s: torch.randn(*s, dtype=torch.bfloat16) * 0.1)(Fh, D))}
    _B_in = _B_setup()
    return {'A_x': _A_in['x'], 'A_w_r': _A_in['w_r'], 'A_w_i': _A_in['w_i'], 'B_x': _B_in['x'], 'B_w_in': _B_in['w_in'], 'B_w_sp': _B_in['w_sp'], 'B_b_sp': _B_in['b_sp'], 'B_w_out': _B_in['w_out']}

def reference(A_x, A_w_r, A_w_i, B_x, B_w_in, B_w_sp, B_b_sp, B_w_out):

    def _A_ref(x, w_r, w_i):
        B, S, D = x.shape
        X = (lambda x, axes=(-2, -1): torch.fft.rfft2(x.float(), dim=axes))(x, axes=(-2, -1))
        W = w_r + 1j * w_i
        X = X * W
        y = (lambda x, s, axes=(-2, -1): torch.fft.irfft2(x, s=s, dim=axes).to(torch.bfloat16))(X, (S, D), axes=(-2, -1))
        return y

    def _B_ref(x, w_in, w_sp, b_sp, w_out):
        B, S, D = x.shape
        F = w_in.shape[-1]
        Fh = F // 2
        z = _gelu(torch.einsum('bsd,df->bsf', x, w_in))
        z1 = z[..., :Fh].clone()
        z2 = _layernorm(z[..., Fh:], axis=-1)
        g = torch.einsum('ts,bsf->btf', w_sp, z2) + b_sp[None, :, None]
        return torch.einsum('bsf,fd->bsd', z1 * g, w_out)
    x = A_x
    xn = _layernorm(x, axis=-1)
    s = _A_ref(xn, A_w_r, A_w_i)
    g = _silu(_B_ref(xn, B_w_in, B_w_sp, B_b_sp, B_w_out))
    return x + s * g
```

```asm
; @launch grid=(256,1,1) block=(256,1,1) lds=163840
.amdgcn_target "amdgcn-amd-amdhsa--gfx950"
.text
.globl recurrent_scan__spectral_gfnet__mixer_gmlp__prompt_kernel
.p2align 8
.type recurrent_scan__spectral_gfnet__mixer_gmlp__prompt_kernel,@function
recurrent_scan__spectral_gfnet__mixer_gmlp__prompt_kernel:
    s_cmp_ge_u32 s2, 256
    s_cbranch_scc1 L_end
    s_load_dwordx2 s[8:9], s[0:1], 0
    s_load_dwordx2 s[20:21], s[0:1], 32
    s_getpc_b64 s[44:45]
L_pc0:
    s_lshr_b32 s53, s2, 3
    v_lshlrev_b32 v1, 7, v0
    v_mov_b32 v7, 1073741824
    v_cmp_gt_u32 vcc, 16, v0
    s_mov_b32 s46, L_end-L_pc0
    s_mov_b32 s47, 0x20000
    s_lshl_b32 s52, s53, 11
    v_cndmask_b32 v1, v7, v1, vcc
    buffer_load_dword v119, v1, s[44:47], s52 offen
    v_lshrrev_b32 v1, 6, v0
    s_and_b32 s52, s2, 7
    v_readfirstlane_b32 s50, v1
    s_and_b32 s54, s53, 3
    s_lshl2_add_u32 s48, s52, s54
    s_lshr_b32 s49, s2, 5
    s_mov_b32 s10, 2097152
    s_mov_b32 s11, 0x20000
    s_mov_b32 s22, 1409024
    s_mov_b32 s23, 0x20000
    v_lshrrev_b32 v1, 3, v0
    v_lshrrev_b32 v2, 4, v0
    v_xor_b32 v2, v2, v0
    v_and_b32 v2, 7, v2
    v_lshlrev_b32 v2, 4, v2
    v_lshl_add_u32 v18, v1, 10, v2
    v_add_u32 v19, 32768, v18
    s_add_u32 s6, s48, s49
    s_lshl_b32 s6, s6, 1
    s_and_b32 s6, s6, 7
    s_lshl_b32 s74, s48, 9
    s_add_u32 s74, s74, s6
    s_lshl_b32 s74, s74, 7
    s_lshl_b32 s76, s50, 10
    v_lshrrev_b32 v1, 2, v0
    v_lshrrev_b32 v2, 4, v0
    v_and_b32 v2, 2, v2
    v_and_b32 v3, 3, v0
    v_xor_b32 v3, v3, v2
    v_cmp_eq_u32 vcc, 3, v3
    v_mul_u32_u24 v1, 2752, v1
    v_lshl_add_u32 v8, v3, 4, v1
    s_lshl_b32 s81, s6, 6
    s_max_u32 s52, s49, 1
    s_min_u32 s52, s52, 4
    s_mul_i32 s5, s49, 5
    s_add_u32 s5, s5, s52
    s_sub_u32 s5, s5, 1
    v_cndmask_b32 v9, v8, v7, vcc
    s_sub_u32 s52, s49, 1
    s_cmp_lt_u32 s52, 3
    s_cselect_b32 s78, 4, 2
    v_cmp_gt_u32 vcc, s78, v3
    s_lshl_b32 s75, s5, 5
    s_add_u32 s75, s75, 1376
    s_mul_i32 s55, s50, 3072
    v_cndmask_b32 v10, v7, v8, vcc
    s_waitcnt lgkmcnt(0)
    s_add_u32 m0, s76, 0
    s_nop 0
    buffer_load_dwordx4 v18, s[8:11], s74 offen lds
    s_add_u32 m0, s76, 4096
    s_nop 0
    buffer_load_dwordx4 v19, s[8:11], s74 offen lds
    s_mul_i32 s83, s6, 176128
    s_add_u32 m0, s55, 65536
    s_add_u32 s83, s83, s75
    buffer_load_dwordx4 v8, s[20:23], s83 offen lds
    s_add_u32 m0, s55, 66496
    s_add_u32 s6, s6, 1
    buffer_load_dwordx4 v8, s[20:23], s83 offen offset:64 lds
    s_add_u32 m0, s55, 67456
    s_and_b32 s6, s6, 7
    buffer_load_dwordx4 v10, s[20:23], s83 offen offset:128 lds
    s_add_u32 m0, s76, 8192
    s_add_u32 s74, s74, 128
    s_and_b32 s74, s74, 0xfffffbff
    buffer_load_dwordx4 v18, s[8:11], s74 offen lds
    s_add_u32 m0, s76, 12288
    s_nop 0
    buffer_load_dwordx4 v19, s[8:11], s74 offen lds
    s_load_dwordx2 s[28:29], s[0:1], 48
    s_load_dwordx2 s[40:41], s[0:1], 80
    s_load_dwordx2 s[12:13], s[0:1], 8
    s_load_dwordx2 s[16:17], s[0:1], 16
    s_load_dwordx2 s[24:25], s[0:1], 40
    s_load_dwordx2 s[32:33], s[0:1], 56
    s_load_dwordx2 s[36:37], s[0:1], 64
    s_lshr_b32 s72, s50, 1
    s_and_b32 s73, s50, 1
    s_mov_b32 s70, s48
    s_mov_b32 s71, s49
    v_bfe_u32 v1, v0, 3, 3
    v_and_b32 v2, 7, v0
    v_bfe_u32 v3, v0, 4, 2
    v_xor_b32 v5, v2, v3
    v_lshlrev_b32 v5, 4, v5
    v_lshl_add_u32 v108, v1, 12, v5
    s_mov_b32 s30, 4096
    s_mov_b32 s31, 0x20000
    s_mov_b32 s42, 16777216
    s_mov_b32 s43, 0x20000
    s_mov_b32 s14, 1052672
    s_mov_b32 s15, 0x20000
    s_mov_b32 s18, 1052672
    s_mov_b32 s19, 0x20000
    s_mov_b32 s26, 8388608
    s_mov_b32 s27, 0x20000
    s_mov_b32 s34, 704512
    s_mov_b32 s35, 0x20000
    s_mov_b32 s38, 2097152
    s_mov_b32 s39, 0x20000
    v_bfe_u32 v6, v0, 5, 1
    v_lshlrev_b32 v6, 3, v6
    s_lshl_b32 s80, s48, 7
    s_lshl4_add_u32 s80, s50, s80
    v_xor_b32 v109, 64, v108
    v_add_u32 v109, 31744, v109
    v_and_b32 v48, 15, v0
    v_bfe_u32 v50, v0, 4, 2
    v_lshrrev_b32 v49, 1, v48
    v_xor_b32 v49, v49, v50
    v_lshlrev_b32 v49, 4, v49
    v_lshl_add_u32 v49, v48, 7, v49
    s_lshl_b32 s53, s50, 11
    v_add_u32 v11, s53, v49
    v_xor_b32 v12, 64, v11
    v_xor_b32 v13, 2048, v11
    v_xor_b32 v14, 2048, v12
    v_and_b32 v52, 1, v50
    v_bfe_u32 v51, v0, 2, 2
    v_lshl_add_u32 v51, v52, 3, v51
    v_lshlrev_b32 v51, 6, v51
    v_bfe_u32 v53, v0, 5, 1
    v_mul_u32_u24 v53, 3072, v53
    v_add_u32 v51, v51, v53
    v_and_b32 v53, 3, v0
    v_lshl_add_u32 v51, v53, 3, v51
    s_mul_i32 s54, s73, 3
    s_add_u32 s53, s54, 0
    v_xor_b32 v53, s53, v52
    v_and_b32 v53, 1, v53
    s_lshr_b32 s53, s53, 1
    s_lshl_b32 s53, s53, 10
    s_add_u32 s53, s53, 65536
    v_lshl_add_u32 v53, v53, 5, v51
    v_add_u32 v15, s53, v53
    s_add_u32 s53, s54, 1
    v_xor_b32 v53, s53, v52
    v_and_b32 v53, 1, v53
    s_lshr_b32 s53, s53, 1
    s_lshl_b32 s53, s53, 10
    s_add_u32 s53, s53, 65536
    v_lshl_add_u32 v53, v53, 5, v51
    v_add_u32 v16, s53, v53
    s_add_u32 s53, s54, 2
    v_xor_b32 v53, s53, v52
    v_and_b32 v53, 1, v53
    s_lshr_b32 s53, s53, 1
    s_lshl_b32 s53, s53, 10
    s_add_u32 s53, s53, 65536
    v_lshl_add_u32 v53, v53, 5, v51
    v_add_u32 v17, s53, v53
    s_mul_i32 s54, s73, 6912
    s_lshl_b32 s53, s50, 5
    s_add_u32 s54, s54, s53
    s_add_u32 s54, s54, 114688
    v_mul_u32_u24 v49, 144, v48
    v_lshl_add_u32 v49, v50, 3, v49
    v_add_u32 v124, s54, v49
    s_lshl_b32 s53, s73, 6
    s_sub_u32 s54, s54, s53
    s_add_u32 s54, s54, 32
    v_add_u32 v125, s54, v49
    v_lshrrev_b32 v49, 3, v0
    v_and_b32 v51, 7, v0
    v_lshlrev_b32 v51, 4, v51
    v_lshl_add_u32 v126, v49, 12, v51
    v_mul_u32_u24 v49, 144, v49
    v_add_u32 v127, v49, v51
    v_add_u32 v110, 63488, v108
    v_add_u32 v111, 63488, v109
    v_add_u32 v112, 131072, v108
    v_add_u32 v113, 131072, v109
    v_add_u32 v114, 194560, v108
    v_add_u32 v115, 194560, v109
    v_add_u32 v116, 262144, v108
    v_add_u32 v117, 262144, v109
    v_add_u32 v118, 325632, v108
    v_and_b32 v49, 63, v0
    v_mov_b32 v51, 1073741824
    v_cmp_gt_u32 vcc, 48, v49
    s_nop 1
    v_cndmask_b32 v118, v51, v118, vcc
    s_lshl_b32 s7, s49, 7
    s_lshl_b32 s68, s50, 13
    s_add_u32 s62, s68, 128512
    s_cmp_eq_u32 s50, 0
    s_cselect_b32 s62, 114688, s62
    s_lshl_b32 s77, s48, 18
    s_lshl_b32 s53, s50, 10
    s_add_u32 s77, s77, s53
    v_and_b32 v1, 3, v0
    v_cmp_eq_u32 s[56:57], 1, v1
    v_cmp_eq_u32 s[58:59], 2, v1
    v_cmp_eq_u32 s[60:61], 3, v1
    v_and_b32 v1, 15, v0
    s_lshl_b32 s52, s73, 4
    v_add_u32 v2, s52, v1
    s_mov_b32 s64, 0xbdd2d3e8
    s_mov_b32 s65, 0xbdd2d3e8
    s_mov_b32 s66, 1.0
    s_mov_b32 s67, 1.0
    v_mov_b32 v20, 0x3f803f80
    v_mov_b32 v21, 0x3f803f80
    v_mov_b32 v22, 0x3f803f80
    v_mov_b32 v23, 0x3f803f80
    s_lshl_b32 s53, s49, 5
    s_add_u32 s53, s53, 1
    v_add_u32 v2, s53, v2
    v_cvt_f32_u32 v2, v2
    v_mul_f32 v2, 0xbb000000, v2
    v_bfe_u32 v3, v0, 4, 2
    v_lshlrev_b32 v3, 3, v3
    v_add_u32 v4, s81, v3
    v_cvt_f32_u32 v3, v3
    v_cvt_f32_u32 v4, v4
    v_mul_f32 v4, v2, v4
    v_fract_f32 v4, v4
    s_lshl_b32 s52, s50, 4
    v_add_u32 v5, s52, v1
    s_waitcnt lgkmcnt(0)
    s_load_dword s51, s[40:41], 0
    v_cmp_eq_u32 vcc, 0, v0
    v_mov_b32 v48, 1073741824
    s_lshl_b32 s52, s48, 18
    v_cndmask_b32 v7, v48, 0, vcc
    buffer_load_dword v119, v7, s[24:27], s52 offen
    buffer_load_dword v119, v7, s[12:15], 0 offen
    buffer_load_dword v119, v7, s[16:19], 0 offen
    buffer_load_dword v119, v7, s[32:35], 0 offen
    v_cmp_gt_u32 vcc, 22, v0
    v_lshlrev_b32 v49, 7, v0
    s_mul_i32 s52, s2, 2816
    v_cndmask_b32 v49, v48, v49, vcc
    buffer_load_dword v119, v49, s[32:35], s52 offen
    v_cmp_gt_u32 vcc, 43, v0
    v_lshlrev_b32 v49, 7, v0
    s_mul_i32 s52, s2, 5504
    v_cndmask_b32 v49, v48, v49, vcc
    buffer_load_dword v119, v49, s[20:23], s52 offen
    s_mov_b32 s52, 0xb0000
    buffer_load_dword v119, v7, s[40:43], s52 offen
    v_mov_b32 v24, v4
    v_fmamk_f32 v25, v2, 0x3f800000, v4
    v_cos_f32 v26, v24
    v_cos_f32 v27, v25
    v_sin_f32 v28, v24
    v_sin_f32 v29, v25
    v_fmamk_f32 v30, v2, 0x40000000, v4
    v_fmamk_f32 v31, v2, 0x40400000, v4
    v_cvt_pk_bf16_f32 v128, v26, v27
    v_cvt_pk_bf16_f32 v132, v28, v29
    v_cos_f32 v32, v30
    v_cos_f32 v33, v31
    v_sin_f32 v34, v30
    v_sin_f32 v35, v31
    v_fmamk_f32 v24, v2, 0x40800000, v4
    v_fmamk_f32 v25, v2, 0x40a00000, v4
    v_cvt_pk_bf16_f32 v129, v32, v33
    v_cvt_pk_bf16_f32 v133, v34, v35
    v_cos_f32 v26, v24
    v_cos_f32 v27, v25
    v_sin_f32 v28, v24
    v_sin_f32 v29, v25
    v_fmamk_f32 v30, v2, 0x40c00000, v4
    v_fmamk_f32 v31, v2, 0x40e00000, v4
    v_cvt_pk_bf16_f32 v130, v26, v27
    v_cvt_pk_bf16_f32 v134, v28, v29
    v_cos_f32 v32, v30
    v_cos_f32 v33, v31
    v_sin_f32 v34, v30
    v_sin_f32 v35, v31
    v_fmamk_f32 v24, v2, 0x42000000, v4
    v_fmamk_f32 v25, v2, 0x42040000, v4
    v_cvt_pk_bf16_f32 v131, v32, v33
    v_cvt_pk_bf16_f32 v135, v34, v35
    v_cos_f32 v26, v24
    v_cos_f32 v27, v25
    v_sin_f32 v28, v24
    v_sin_f32 v29, v25
    v_fmamk_f32 v30, v2, 0x42080000, v4
    v_fmamk_f32 v31, v2, 0x420c0000, v4
    v_cvt_pk_bf16_f32 v136, v26, v27
    v_cvt_pk_bf16_f32 v140, v28, v29
    v_cos_f32 v32, v30
    v_cos_f32 v33, v31
    v_sin_f32 v34, v30
    v_sin_f32 v35, v31
    v_fmamk_f32 v24, v2, 0x42100000, v4
    v_fmamk_f32 v25, v2, 0x42140000, v4
    v_cvt_pk_bf16_f32 v137, v32, v33
    v_cvt_pk_bf16_f32 v141, v34, v35
    v_cos_f32 v26, v24
    v_cos_f32 v27, v25
    v_sin_f32 v28, v24
    v_sin_f32 v29, v25
    v_fmamk_f32 v30, v2, 0x42180000, v4
    v_fmamk_f32 v31, v2, 0x421c0000, v4
    v_cvt_pk_bf16_f32 v138, v26, v27
    v_cvt_pk_bf16_f32 v142, v28, v29
    v_cos_f32 v32, v30
    v_cos_f32 v33, v31
    v_sin_f32 v34, v30
    v_sin_f32 v35, v31
    v_fmamk_f32 v24, v2, 0x42800000, v4
    v_fmamk_f32 v25, v2, 0x42820000, v4
    v_cvt_pk_bf16_f32 v139, v32, v33
    v_cvt_pk_bf16_f32 v143, v34, v35
    v_cos_f32 v26, v24
    v_cos_f32 v27, v25
    v_sin_f32 v28, v24
    v_sin_f32 v29, v25
    v_fmamk_f32 v30, v2, 0x42840000, v4
    v_fmamk_f32 v31, v2, 0x42860000, v4
    v_cvt_pk_bf16_f32 v144, v26, v27
    v_cvt_pk_bf16_f32 v148, v28, v29
    v_cos_f32 v32, v30
    v_cos_f32 v33, v31
    v_sin_f32 v34, v30
    v_sin_f32 v35, v31
    v_fmamk_f32 v24, v2, 0x42880000, v4
    v_fmamk_f32 v25, v2, 0x428a0000, v4
    v_cvt_pk_bf16_f32 v145, v32, v33
    v_cvt_pk_bf16_f32 v149, v34, v35
    v_cos_f32 v26, v24
    v_cos_f32 v27, v25
    v_sin_f32 v28, v24
    v_sin_f32 v29, v25
    v_fmamk_f32 v30, v2, 0x428c0000, v4
    v_fmamk_f32 v31, v2, 0x428e0000, v4
    v_cvt_pk_bf16_f32 v146, v26, v27
    v_cvt_pk_bf16_f32 v150, v28, v29
    v_cos_f32 v32, v30
    v_cos_f32 v33, v31
    v_sin_f32 v34, v30
    v_sin_f32 v35, v31
    v_fmamk_f32 v24, v2, 0x42c00000, v4
    v_fmamk_f32 v25, v2, 0x42c20000, v4
    v_cvt_pk_bf16_f32 v147, v32, v33
    v_cvt_pk_bf16_f32 v151, v34, v35
    v_cos_f32 v26, v24
    v_cos_f32 v27, v25
    v_sin_f32 v28, v24
    v_sin_f32 v29, v25
    v_fmamk_f32 v30, v2, 0x42c40000, v4
    v_fmamk_f32 v31, v2, 0x42c60000, v4
    v_cvt_pk_bf16_f32 v152, v26, v27
    v_cvt_pk_bf16_f32 v156, v28, v29
    v_cos_f32 v32, v30
    v_cos_f32 v33, v31
    v_sin_f32 v34, v30
    v_sin_f32 v35, v31
    v_fmamk_f32 v24, v2, 0x42c80000, v4
    v_fmamk_f32 v25, v2, 0x42ca0000, v4
    v_cvt_pk_bf16_f32 v153, v32, v33
    v_cvt_pk_bf16_f32 v157, v34, v35
    v_cos_f32 v26, v24
    v_cos_f32 v27, v25
    v_sin_f32 v28, v24
    v_sin_f32 v29, v25
    v_fmamk_f32 v30, v2, 0x42cc0000, v4
    v_fmamk_f32 v31, v2, 0x42ce0000, v4
    v_cvt_pk_bf16_f32 v154, v26, v27
    v_cvt_pk_bf16_f32 v158, v28, v29
    v_cos_f32 v32, v30
    v_cos_f32 v33, v31
    v_sin_f32 v34, v30
    v_sin_f32 v35, v31
    v_cvt_pk_bf16_f32 v155, v32, v33
    v_cvt_pk_bf16_f32 v159, v34, v35
    v_add_u32 v2, 1, v0
    v_and_b32 v4, 1, v2
    v_cmp_eq_u32 s[100:101], 1, v4
    v_bfe_i32 v4, v2, 1, 1
    v_and_b32 v4, 0x80008000, v4
    buffer_load_dwordx2 v[120:121], v6, s[28:31], s80 offen offset:0
    buffer_load_dwordx2 v[122:123], v6, s[28:31], s80 offen offset:64
    v_bfe_i32 v2, v0, 1, 1
    v_not_b32 v2, v2
    v_and_b32 v2, 0x80008000, v2
    v_cndmask_b32 v160, v128, v132, s[100:101]
    v_cndmask_b32 v164, v132, v128, s[100:101]
    v_xor_b32 v160, v4, v160
    v_xor_b32 v164, v2, v164
    v_cndmask_b32 v161, v129, v133, s[100:101]
    v_cndmask_b32 v165, v133, v129, s[100:101]
    v_xor_b32 v161, v4, v161
    v_xor_b32 v165, v2, v165
    v_cndmask_b32 v162, v130, v134, s[100:101]
    v_cndmask_b32 v166, v134, v130, s[100:101]
    v_xor_b32 v162, v4, v162
    v_xor_b32 v166, v2, v166
    s_mul_i32 s83, s6, 176128
    s_add_u32 m0, s55, 77824
    s_add_u32 s83, s83, s75
    buffer_load_dwordx4 v8, s[20:23], s83 offen lds
    v_cndmask_b32 v163, v131, v135, s[100:101]
    v_cndmask_b32 v167, v135, v131, s[100:101]
    v_xor_b32 v163, v4, v163
    v_xor_b32 v167, v2, v167
    v_cndmask_b32 v168, v136, v140, s[100:101]
    v_cndmask_b32 v172, v140, v136, s[100:101]
    v_xor_b32 v168, v4, v168
    v_xor_b32 v172, v2, v172
    v_cndmask_b32 v169, v137, v141, s[100:101]
    v_cndmask_b32 v173, v141, v137, s[100:101]
    v_xor_b32 v169, v4, v169
    v_xor_b32 v173, v2, v173
    v_cndmask_b32 v170, v138, v142, s[100:101]
    v_cndmask_b32 v174, v142, v138, s[100:101]
    s_add_u32 m0, s55, 78784
    s_add_u32 s6, s6, 1
    buffer_load_dwordx4 v8, s[20:23], s83 offen offset:64 lds
    v_xor_b32 v170, v4, v170
    v_xor_b32 v174, v2, v174
    v_cndmask_b32 v171, v139, v143, s[100:101]
    v_cndmask_b32 v175, v143, v139, s[100:101]
    v_xor_b32 v171, v4, v171
    v_xor_b32 v175, v2, v175
    v_cndmask_b32 v176, v144, v148, s[100:101]
    v_cndmask_b32 v180, v148, v144, s[100:101]
    v_xor_b32 v176, v4, v176
    v_xor_b32 v180, v2, v180
    v_cndmask_b32 v177, v145, v149, s[100:101]
    v_cndmask_b32 v181, v149, v145, s[100:101]
    v_xor_b32 v177, v4, v177
    v_xor_b32 v181, v2, v181
    v_cndmask_b32 v178, v146, v150, s[100:101]
    s_add_u32 m0, s55, 79744
    s_and_b32 s6, s6, 7
    buffer_load_dwordx4 v10, s[20:23], s83 offen offset:128 lds
    v_cndmask_b32 v182, v150, v146, s[100:101]
    v_xor_b32 v178, v4, v178
    v_xor_b32 v182, v2, v182
    v_cndmask_b32 v179, v147, v151, s[100:101]
    v_cndmask_b32 v183, v151, v147, s[100:101]
    v_xor_b32 v179, v4, v179
    v_xor_b32 v183, v2, v183
    v_cndmask_b32 v184, v152, v156, s[100:101]
    v_cndmask_b32 v188, v156, v152, s[100:101]
    v_xor_b32 v184, v4, v184
    v_xor_b32 v188, v2, v188
    v_cndmask_b32 v185, v153, v157, s[100:101]
    v_cndmask_b32 v189, v157, v153, s[100:101]
    v_xor_b32 v185, v4, v185
    v_xor_b32 v189, v2, v189
    s_add_u32 m0, s76, 16384
    s_add_u32 s74, s74, 128
    s_and_b32 s74, s74, 0xfffffbff
    buffer_load_dwordx4 v18, s[8:11], s74 offen lds
    v_cndmask_b32 v186, v154, v158, s[100:101]
    v_cndmask_b32 v190, v158, v154, s[100:101]
    v_xor_b32 v186, v4, v186
    v_xor_b32 v190, v2, v190
    v_cndmask_b32 v187, v155, v159, s[100:101]
    v_cndmask_b32 v191, v159, v155, s[100:101]
    v_xor_b32 v187, v4, v187
    v_xor_b32 v191, v2, v191
    v_cvt_f32_u32 v2, v5
    v_mul_f32 v5, 0x3c800000, v2
    v_mul_f32 v4, v5, v3
    v_mov_b32 v92, v4
    v_fmamk_f32 v93, v5, 0x3f800000, v4
    v_cos_f32 v94, v92
    s_add_u32 m0, s76, 20480
    s_nop 0
    buffer_load_dwordx4 v19, s[8:11], s74 offen lds
    v_cos_f32 v95, v93
    v_sin_f32 v96, v92
    v_sin_f32 v97, v93
    v_fmamk_f32 v98, v5, 0x40000000, v4
    v_fmamk_f32 v99, v5, 0x40400000, v4
    v_cvt_pk_bf16_f32 v192, v94, v95
    v_cvt_pk_bf16_f32 v200, v96, v97
    v_cos_f32 v100, v98
    v_cos_f32 v101, v99
    s_mul_i32 s83, s6, 176128
    s_add_u32 m0, s55, 90112
    s_add_u32 s83, s83, s75
    buffer_load_dwordx4 v8, s[20:23], s83 offen lds
    v_sin_f32 v102, v98
    v_sin_f32 v103, v99
    v_fmamk_f32 v92, v5, 0x40800000, v4
    v_fmamk_f32 v93, v5, 0x40a00000, v4
    v_cvt_pk_bf16_f32 v193, v100, v101
    v_cvt_pk_bf16_f32 v201, v102, v103
    v_cos_f32 v94, v92
    v_cos_f32 v95, v93
    v_sin_f32 v96, v92
    s_add_u32 m0, s55, 91072
    s_add_u32 s6, s6, 1
    buffer_load_dwordx4 v8, s[20:23], s83 offen offset:64 lds
    v_sin_f32 v97, v93
    v_fmamk_f32 v98, v5, 0x40c00000, v4
    v_fmamk_f32 v99, v5, 0x40e00000, v4
    v_cvt_pk_bf16_f32 v194, v94, v95
    v_cvt_pk_bf16_f32 v202, v96, v97
    v_cos_f32 v100, v98
    v_cos_f32 v101, v99
    v_sin_f32 v102, v98
    v_sin_f32 v103, v99
    v_cvt_pk_bf16_f32 v195, v100, v101
    s_add_u32 m0, s55, 92032
    s_and_b32 s6, s6, 7
    buffer_load_dwordx4 v10, s[20:23], s83 offen offset:128 lds
    v_cvt_pk_bf16_f32 v203, v102, v103
    v_bfe_i32 v4, v0, 0, 1
    v_and_b32 v4, 0x80008000, v4
    v_xor_b32 v196, v4, v192
    v_xor_b32 v204, v4, v200
    v_xor_b32 v197, v4, v193
    v_xor_b32 v205, v4, v201
    v_xor_b32 v198, v4, v194
    v_xor_b32 v206, v4, v202
    v_xor_b32 v199, v4, v195
    v_xor_b32 v207, v4, v203
    v_mul_f32 v5, 0x3a000000, v2
    v_mul_f32 v4, v5, v3
    v_mov_b32 v92, v4
    s_waitcnt lgkmcnt(0)
    s_add_u32 s51, s51, 0x9e3779b9
    s_waitcnt vmcnt(22)
    s_waitcnt vmcnt(19)
    s_barrier
    ds_read_b128 a[0:3], v11 offset:0
    ds_read_b64_tr_b16 v[24:25], v15 offset:0
    ds_read_b128 a[4:7], v13 offset:0
    ds_read_b64_tr_b16 v[26:27], v15 offset:256
    ds_read_b64_tr_b16 v[28:29], v16 offset:0
    ds_read_b64_tr_b16 v[30:31], v16 offset:256
    ds_read_b64_tr_b16 v[32:33], v17 offset:0
    ds_read_b64_tr_b16 v[34:35], v17 offset:256
    s_waitcnt lgkmcnt(4)
    v_mfma_f32_16x16x32_bf16 v[48:51], a[0:3], v[24:27], 0
    ds_read_b128 a[8:11], v12 offset:0
    s_mul_i32 s83, s6, 176128
    s_add_u32 m0, s55, 102400
    s_add_u32 s83, s83, s75
    v_mfma_f32_16x16x32_bf16 v[60:63], a[4:7], v[24:27], 0
    buffer_load_dwordx4 v8, s[20:23], s83 offen lds
    ds_read_b64_tr_b16 v[36:37], v15 offset:6144
    v_mfma_f32_16x16x32_bf16 v[72:75], v[20:23], v[24:27], 0
    ds_read_b128 a[12:15], v14 offset:0
    v_cos_f32 v240, v92
    s_waitcnt lgkmcnt(5)
    v_mfma_f32_16x16x32_bf16 v[52:55], a[0:3], v[28:31], 0
    ds_read_b64_tr_b16 v[38:39], v15 offset:6400
    v_mfma_f32_16x16x32_bf16 v[64:67], a[4:7], v[28:31], 0
    ds_read_b64_tr_b16 v[40:41], v16 offset:6144
    v_sin_f32 v248, v92
    v_mfma_f32_16x16x32_bf16 v[76:79], v[20:23], v[28:31], 0
    ds_read_b64_tr_b16 v[42:43], v16 offset:6400
    v_fmamk_f32 v93, v5, 0x3f800000, v4
    s_waitcnt lgkmcnt(6)
    v_mfma_f32_16x16x32_bf16 v[56:59], a[0:3], v[32:35], 0
    ds_read_b64_tr_b16 v[44:45], v17 offset:6144
    v_cos_f32 v241, v93
    v_mfma_f32_16x16x32_bf16 v[68:71], a[4:7], v[32:35], 0
    ds_read_b64_tr_b16 v[46:47], v17 offset:6400
    v_sin_f32 v249, v93
    s_add_u32 m0, s55, 103360
    s_add_u32 s6, s6, 1
    v_mfma_f32_16x16x32_bf16 v[80:83], v[20:23], v[32:35], 0
    buffer_load_dwordx4 v8, s[20:23], s83 offen offset:64 lds
    v_mfma_f32_16x16x32_bf16 v[84:87], a[0:3], v[20:23], 0
    v_fmamk_f32 v94, v5, 0x40000000, v4
    v_mfma_f32_16x16x32_bf16 v[88:91], a[0:3], a[0:3], 0
    v_cos_f32 v242, v94
    v_sin_f32 v250, v94
    s_add_u32 m0, s55, 104320
    s_and_b32 s6, s6, 7
    s_waitcnt lgkmcnt(4)
    v_mfma_f32_16x16x32_bf16 v[48:51], a[8:11], v[36:39], v[48:51]
    buffer_load_dwordx4 v10, s[20:23], s83 offen offset:128 lds
    v_mfma_f32_16x16x32_bf16 v[60:63], a[12:15], v[36:39], v[60:63]
    v_fmamk_f32 v95, v5, 0x40400000, v4
    v_cos_f32 v243, v95
    v_mfma_f32_16x16x32_bf16 v[72:75], v[20:23], v[36:39], v[72:75]
    v_sin_f32 v251, v95
    s_waitcnt vmcnt(20)
    s_waitcnt vmcnt(8)
    s_waitcnt lgkmcnt(0)
    s_barrier
    ds_read_b128 a[16:19], v11 offset:8192
    v_fmamk_f32 v92, v5, 0x40800000, v4
    s_add_u32 m0, s76, 24576
    s_add_u32 s74, s74, 128
    s_and_b32 s74, s74, 0xfffffbff
    v_mfma_f32_16x16x32_bf16 v[52:55], a[8:11], v[40:43], v[52:55]
    buffer_load_dwordx4 v18, s[8:11], s74 offen lds
    ds_read_b64_tr_b16 v[24:25], v15 offset:12288
    v_mfma_f32_16x16x32_bf16 v[64:67], a[12:15], v[40:43], v[64:67]
    ds_read_b128 a[20:23], v13 offset:8192
    v_mfma_f32_16x16x32_bf16 v[76:79], v[20:23], v[40:43], v[76:79]
    ds_read_b64_tr_b16 v[26:27], v15 offset:12544
    v_cos_f32 v244, v92
    v_mfma_f32_16x16x32_bf16 v[56:59], a[8:11], v[44:47], v[56:59]
    ds_read_b64_tr_b16 v[28:29], v16 offset:12288
    v_sin_f32 v252, v92
    v_mfma_f32_16x16x32_bf16 v[68:71], a[12:15], v[44:47], v[68:71]
    ds_read_b64_tr_b16 v[30:31], v16 offset:12544
    v_mfma_f32_16x16x32_bf16 v[80:83], v[20:23], v[44:47], v[80:83]
    ds_read_b64_tr_b16 v[32:33], v17 offset:12288
    v_fmamk_f32 v93, v5, 0x40a00000, v4
    v_mfma_f32_16x16x32_bf16 v[84:87], a[8:11], v[20:23], v[84:87]
    ds_read_b64_tr_b16 v[34:35], v17 offset:12544
    v_cos_f32 v245, v93
    s_add_u32 m0, s76, 28672
    v_mfma_f32_16x16x32_bf16 v[88:91], a[8:11], a[8:11], v[88:91]
    buffer_load_dwordx4 v19, s[8:11], s74 offen lds
    s_waitcnt lgkmcnt(4)
    v_mfma_f32_16x16x32_bf16 v[48:51], a[16:19], v[24:27], v[48:51]
    ds_read_b128 a[24:27], v12 offset:8192
    s_mul_i32 s83, s6, 176128
    s_add_u32 m0, s55, 65536
    s_add_u32 s83, s83, s75
    v_mfma_f32_16x16x32_bf16 v[60:63], a[20:23], v[24:27], v[60:63]
    buffer_load_dwordx4 v8, s[20:23], s83 offen lds
    ds_read_b64_tr_b16 v[36:37], v15 offset:18432
    v_mfma_f32_16x16x32_bf16 v[72:75], v[20:23], v[24:27], v[72:75]
    ds_read_b128 a[28:31], v14 offset:8192
    v_sin_f32 v253, v93
    s_waitcnt lgkmcnt(5)
    v_mfma_f32_16x16x32_bf16 v[52:55], a[16:19], v[28:31], v[52:55]
    ds_read_b64_tr_b16 v[38:39], v15 offset:18688
    v_mfma_f32_16x16x32_bf16 v[64:67], a[20:23], v[28:31], v[64:67]
    ds_read_b64_tr_b16 v[40:41], v16 offset:18432
    v_fmamk_f32 v94, v5, 0x40c00000, v4
    v_mfma_f32_16x16x32_bf16 v[76:79], v[20:23], v[28:31], v[76:79]
    ds_read_b64_tr_b16 v[42:43], v16 offset:18688
    v_cos_f32 v246, v94
    s_waitcnt lgkmcnt(6)
    v_mfma_f32_16x16x32_bf16 v[56:59], a[16:19], v[32:35], v[56:59]
    ds_read_b64_tr_b16 v[44:45], v17 offset:18432
    v_mfma_f32_16x16x32_bf16 v[68:71], a[20:23], v[32:35], v[68:71]
    ds_read_b64_tr_b16 v[46:47], v17 offset:18688
    v_sin_f32 v254, v94
    s_add_u32 m0, s55, 66496
    s_add_u32 s6, s6, 1
    v_mfma_f32_16x16x32_bf16 v[80:83], v[20:23], v[32:35], v[80:83]
    buffer_load_dwordx4 v8, s[20:23], s83 offen offset:64 lds
    v_mfma_f32_16x16x32_bf16 v[84:87], a[16:19], v[20:23], v[84:87]
    v_fmamk_f32 v95, v5, 0x40e00000, v4
    v_cos_f32 v247, v95
    v_mfma_f32_16x16x32_bf16 v[88:91], a[16:19], a[16:19], v[88:91]
    v_sin_f32 v255, v95
    s_add_u32 m0, s55, 67456
    s_and_b32 s6, s6, 7
    s_waitcnt lgkmcnt(4)
    v_mfma_f32_16x16x32_bf16 v[48:51], a[24:27], v[36:39], v[48:51]
    buffer_load_dwordx4 v10, s[20:23], s83 offen offset:128 lds
    v_mfma_f32_16x16x32_bf16 v[60:63], a[28:31], v[36:39], v[60:63]
    v_lshrrev_b32 v2, 2, v1
    v_and_b32 v5, 3, v1
    v_mfma_f32_16x16x32_bf16 v[72:75], v[20:23], v[36:39], v[72:75]
    v_lshl_add_u32 v2, v2, 3, v5
    v_cvt_f32_u32 v2, v2
    s_waitcnt vmcnt(11)
    s_waitcnt vmcnt(8)
    s_waitcnt lgkmcnt(0)
    s_barrier
    ds_read_b128 a[32:35], v11 offset:16384
    s_add_u32 m0, s76, 32768
    s_add_u32 s74, s74, 128
    s_and_b32 s74, s74, 0xfffffbff
    v_mfma_f32_16x16x32_bf16 v[52:55], a[24:27], v[40:43], v[52:55]
    buffer_load_dwordx4 v18, s[8:11], s74 offen lds
    ds_read_b64_tr_b16 v[24:25], v15 offset:24576
    v_mfma_f32_16x16x32_bf16 v[64:67], a[28:31], v[40:43], v[64:67]
    ds_read_b128 a[36:39], v13 offset:16384
    v_mfma_f32_16x16x32_bf16 v[76:79], v[20:23], v[40:43], v[76:79]
    ds_read_b64_tr_b16 v[26:27], v15 offset:24832
    v_mul_f32 v5, 0x3d000000, v2
    v_mfma_f32_16x16x32_bf16 v[56:59], a[24:27], v[44:47], v[56:59]
    ds_read_b64_tr_b16 v[28:29], v16 offset:24576
    v_mul_f32 v4, v5, v3
    v_mfma_f32_16x16x32_bf16 v[68:71], a[28:31], v[44:47], v[68:71]
    ds_read_b64_tr_b16 v[30:31], v16 offset:24832
    v_mov_b32 v92, v4
    v_mfma_f32_16x16x32_bf16 v[80:83], v[20:23], v[44:47], v[80:83]
    ds_read_b64_tr_b16 v[32:33], v17 offset:24576
    v_fmamk_f32 v93, v5, 0x3f800000, v4
    v_mfma_f32_16x16x32_bf16 v[84:87], a[24:27], v[20:23], v[84:87]
    ds_read_b64_tr_b16 v[34:35], v17 offset:24832
    s_add_u32 m0, s76, 36864
    v_mfma_f32_16x16x32_bf16 v[88:91], a[24:27], a[24:27], v[88:91]
    buffer_load_dwordx4 v19, s[8:11], s74 offen lds
    v_cos_f32 v94, v92
    s_waitcnt lgkmcnt(4)
    v_mfma_f32_16x16x32_bf16 v[48:51], a[32:35], v[24:27], v[48:51]
    ds_read_b128 a[40:43], v12 offset:16384
    s_mul_i32 s83, s6, 176128
    s_add_u32 m0, s55, 77824
    s_add_u32 s83, s83, s75
    v_mfma_f32_16x16x32_bf16 v[60:63], a[36:39], v[24:27], v[60:63]
    buffer_load_dwordx4 v8, s[20:23], s83 offen lds
    ds_read_b64_tr_b16 v[36:37], v15 offset:30720
    v_mfma_f32_16x16x32_bf16 v[72:75], v[20:23], v[24:27], v[72:75]
    ds_read_b128 a[44:47], v14 offset:16384
    v_cos_f32 v95, v93
    s_waitcnt lgkmcnt(5)
    v_mfma_f32_16x16x32_bf16 v[52:55], a[32:35], v[28:31], v[52:55]
    ds_read_b64_tr_b16 v[38:39], v15 offset:30976
    v_mfma_f32_16x16x32_bf16 v[64:67], a[36:39], v[28:31], v[64:67]
    ds_read_b64_tr_b16 v[40:41], v16 offset:30720
    v_sin_f32 v96, v92
    v_mfma_f32_16x16x32_bf16 v[76:79], v[20:23], v[28:31], v[76:79]
    ds_read_b64_tr_b16 v[42:43], v16 offset:30976
    v_sin_f32 v97, v93
    s_waitcnt lgkmcnt(6)
    v_mfma_f32_16x16x32_bf16 v[56:59], a[32:35], v[32:35], v[56:59]
    ds_read_b64_tr_b16 v[44:45], v17 offset:30720
    v_mfma_f32_16x16x32_bf16 v[68:71], a[36:39], v[32:35], v[68:71]
    ds_read_b64_tr_b16 v[46:47], v17 offset:30976
    v_fmamk_f32 v98, v5, 0x40000000, v4
    v_fmamk_f32 v99, v5, 0x40400000, v4
    s_add_u32 m0, s55, 78784
    s_add_u32 s6, s6, 1
    v_mfma_f32_16x16x32_bf16 v[80:83], v[20:23], v[32:35], v[80:83]
    buffer_load_dwordx4 v8, s[20:23], s83 offen offset:64 lds
    v_mfma_f32_16x16x32_bf16 v[84:87], a[32:35], v[20:23], v[84:87]
    v_cvt_pk_bf16_f32 v216, v94, v95
    v_cvt_pk_bf16_f32 v224, v96, v97
    v_mfma_f32_16x16x32_bf16 v[88:91], a[32:35], a[32:35], v[88:91]
    v_cos_f32 v100, v98
    s_add_u32 m0, s55, 79744
    s_and_b32 s6, s6, 7
    s_waitcnt lgkmcnt(4)
    v_mfma_f32_16x16x32_bf16 v[48:51], a[40:43], v[36:39], v[48:51]
    buffer_load_dwordx4 v10, s[20:23], s83 offen offset:128 lds
    v_mfma_f32_16x16x32_bf16 v[60:63], a[44:47], v[36:39], v[60:63]
    v_cos_f32 v101, v99
    v_sin_f32 v102, v98
    v_mfma_f32_16x16x32_bf16 v[72:75], v[20:23], v[36:39], v[72:75]
    v_sin_f32 v103, v99
    s_waitcnt vmcnt(8)
    s_waitcnt lgkmcnt(0)
    s_barrier
    ds_read_b128 a[48:51], v11 offset:24576
    s_add_u32 m0, s76, 40960
    s_add_u32 s74, s74, 128
    s_and_b32 s74, s74, 0xfffffbff
    v_mfma_f32_16x16x32_bf16 v[52:55], a[40:43], v[40:43], v[52:55]
    buffer_load_dwordx4 v18, s[8:11], s74 offen lds
    ds_read_b64_tr_b16 v[24:25], v15 offset:36864
    v_mfma_f32_16x16x32_bf16 v[64:67], a[44:47], v[40:43], v[64:67]
    ds_read_b128 a[52:55], v13 offset:24576
    v_mfma_f32_16x16x32_bf16 v[76:79], v[20:23], v[40:43], v[76:79]
    ds_read_b64_tr_b16 v[26:27], v15 offset:37120
    v_fmamk_f32 v92, v5, 0x40800000, v4
    v_mfma_f32_16x16x32_bf16 v[56:59], a[40:43], v[44:47], v[56:59]
    ds_read_b64_tr_b16 v[28:29], v16 offset:36864
    v_fmamk_f32 v93, v5, 0x40a00000, v4
    v_mfma_f32_16x16x32_bf16 v[68:71], a[44:47], v[44:47], v[68:71]
    ds_read_b64_tr_b16 v[30:31], v16 offset:37120
    v_cvt_pk_bf16_f32 v217, v100, v101
    v_mfma_f32_16x16x32_bf16 v[80:83], v[20:23], v[44:47], v[80:83]
    ds_read_b64_tr_b16 v[32:33], v17 offset:36864
    v_cvt_pk_bf16_f32 v225, v102, v103
    v_mfma_f32_16x16x32_bf16 v[84:87], a[40:43], v[20:23], v[84:87]
    ds_read_b64_tr_b16 v[34:35], v17 offset:37120
    s_add_u32 m0, s76, 45056
    v_mfma_f32_16x16x32_bf16 v[88:91], a[40:43], a[40:43], v[88:91]
    buffer_load_dwordx4 v19, s[8:11], s74 offen lds
    v_cos_f32 v94, v92
    s_waitcnt lgkmcnt(4)
    v_mfma_f32_16x16x32_bf16 v[48:51], a[48:51], v[24:27], v[48:51]
    ds_read_b128 a[56:59], v12 offset:24576
    s_mul_i32 s83, s6, 176128
    s_add_u32 m0, s55, 90112
    s_add_u32 s83, s83, s75
    v_mfma_f32_16x16x32_bf16 v[60:63], a[52:55], v[24:27], v[60:63]
    buffer_load_dwordx4 v8, s[20:23], s83 offen lds
    ds_read_b64_tr_b16 v[36:37], v15 offset:43008
    v_mfma_f32_16x16x32_bf16 v[72:75], v[20:23], v[24:27], v[72:75]
    ds_read_b128 a[60:63], v14 offset:24576
    v_cos_f32 v95, v93
    s_waitcnt lgkmcnt(5)
    v_mfma_f32_16x16x32_bf16 v[52:55], a[48:51], v[28:31], v[52:55]
    ds_read_b64_tr_b16 v[38:39], v15 offset:43264
    v_mfma_f32_16x16x32_bf16 v[64:67], a[52:55], v[28:31], v[64:67]
    ds_read_b64_tr_b16 v[40:41], v16 offset:43008
    v_sin_f32 v96, v92
    v_mfma_f32_16x16x32_bf16 v[76:79], v[20:23], v[28:31], v[76:79]
    ds_read_b64_tr_b16 v[42:43], v16 offset:43264
    v_sin_f32 v97, v93
    s_waitcnt lgkmcnt(6)
    v_mfma_f32_16x16x32_bf16 v[56:59], a[48:51], v[32:35], v[56:59]
    ds_read_b64_tr_b16 v[44:45], v17 offset:43008
    v_mfma_f32_16x16x32_bf16 v[68:71], a[52:55], v[32:35], v[68:71]
    ds_read_b64_tr_b16 v[46:47], v17 offset:43264
    v_fmamk_f32 v98, v5, 0x40c00000, v4
    v_fmamk_f32 v99, v5, 0x40e00000, v4
    s_add_u32 m0, s55, 91072
    s_add_u32 s6, s6, 1
    v_mfma_f32_16x16x32_bf16 v[80:83], v[20:23], v[32:35], v[80:83]
    buffer_load_dwordx4 v8, s[20:23], s83 offen offset:64 lds
    v_mfma_f32_16x16x32_bf16 v[84:87], a[48:51], v[20:23], v[84:87]
    v_cvt_pk_bf16_f32 v218, v94, v95
    v_cvt_pk_bf16_f32 v226, v96, v97
    v_mfma_f32_16x16x32_bf16 v[88:91], a[48:51], a[48:51], v[88:91]
    v_cos_f32 v100, v98
    s_add_u32 m0, s55, 92032
    s_and_b32 s6, s6, 7
    s_waitcnt lgkmcnt(4)
    v_mfma_f32_16x16x32_bf16 v[48:51], a[56:59], v[36:39], v[48:51]
    buffer_load_dwordx4 v10, s[20:23], s83 offen offset:128 lds
    v_mfma_f32_16x16x32_bf16 v[60:63], a[60:63], v[36:39], v[60:63]
    v_cos_f32 v101, v99
    v_sin_f32 v102, v98
    v_mfma_f32_16x16x32_bf16 v[72:75], v[20:23], v[36:39], v[72:75]
    v_sin_f32 v103, v99
    s_waitcnt vmcnt(8)
    s_waitcnt lgkmcnt(0)
    s_barrier
    ds_read_b128 a[64:67], v11 offset:32768
    s_add_u32 m0, s76, 49152
    s_add_u32 s74, s74, 128
    s_and_b32 s74, s74, 0xfffffbff
    v_mfma_f32_16x16x32_bf16 v[52:55], a[56:59], v[40:43], v[52:55]
    buffer_load_dwordx4 v18, s[8:11], s74 offen lds
    ds_read_b64_tr_b16 v[24:25], v15 offset:0
    v_mfma_f32_16x16x32_bf16 v[64:67], a[60:63], v[40:43], v[64:67]
    ds_read_b128 a[68:71], v13 offset:32768
    v_mfma_f32_16x16x32_bf16 v[76:79], v[20:23], v[40:43], v[76:79]
    ds_read_b64_tr_b16 v[26:27], v15 offset:256
    v_cvt_pk_bf16_f32 v219, v100, v101
    v_mfma_f32_16x16x32_bf16 v[56:59], a[56:59], v[44:47], v[56:59]
    ds_read_b64_tr_b16 v[28:29], v16 offset:0
    v_cvt_pk_bf16_f32 v227, v102, v103
    v_mfma_f32_16x16x32_bf16 v[68:71], a[60:63], v[44:47], v[68:71]
    ds_read_b64_tr_b16 v[30:31], v16 offset:256
    v_add_f32 v2, 4.0, v2
    v_mfma_f32_16x16x32_bf16 v[80:83], v[20:23], v[44:47], v[80:83]
    ds_read_b64_tr_b16 v[32:33], v17 offset:0
    v_mul_f32 v5, 0x3d000000, v2
    v_mfma_f32_16x16x32_bf16 v[84:87], a[56:59], v[20:23], v[84:87]
    ds_read_b64_tr_b16 v[34:35], v17 offset:256
    v_mul_f32 v4, v5, v3
    s_add_u32 m0, s76, 53248
    v_mfma_f32_16x16x32_bf16 v[88:91], a[56:59], a[56:59], v[88:91]
    buffer_load_dwordx4 v19, s[8:11], s74 offen lds
    s_waitcnt lgkmcnt(4)
    v_mfma_f32_16x16x32_bf16 v[48:51], a[64:67], v[24:27], v[48:51]
    ds_read_b128 a[72:75], v12 offset:32768
    v_mov_b32 v92, v4
    s_mul_i32 s83, s6, 176128
    s_add_u32 m0, s55, 102400
    s_add_u32 s83, s83, s75
    v_mfma_f32_16x16x32_bf16 v[60:63], a[68:71], v[24:27], v[60:63]
    buffer_load_dwordx4 v8, s[20:23], s83 offen lds
    ds_read_b64_tr_b16 v[36:37], v15 offset:6144
    v_mfma_f32_16x16x32_bf16 v[72:75], v[20:23], v[24:27], v[72:75]
    ds_read_b128 a[76:79], v14 offset:32768
    s_waitcnt lgkmcnt(5)
    v_mfma_f32_16x16x32_bf16 v[52:55], a[64:67], v[28:31], v[52:55]
    ds_read_b64_tr_b16 v[38:39], v15 offset:6400
    v_fmamk_f32 v93, v5, 0x3f800000, v4
    v_mfma_f32_16x16x32_bf16 v[64:67], a[68:71], v[28:31], v[64:67]
    ds_read_b64_tr_b16 v[40:41], v16 offset:6144
    v_cos_f32 v94, v92
    v_mfma_f32_16x16x32_bf16 v[76:79], v[20:23], v[28:31], v[76:79]
    ds_read_b64_tr_b16 v[42:43], v16 offset:6400
    s_waitcnt lgkmcnt(6)
    v_mfma_f32_16x16x32_bf16 v[56:59], a[64:67], v[32:35], v[56:59]
    ds_read_b64_tr_b16 v[44:45], v17 offset:6144
    v_cos_f32 v95, v93
    v_mfma_f32_16x16x32_bf16 v[68:71], a[68:71], v[32:35], v[68:71]
    ds_read_b64_tr_b16 v[46:47], v17 offset:6400
    s_add_u32 m0, s55, 103360
    s_add_u32 s6, s6, 1
    v_mfma_f32_16x16x32_bf16 v[80:83], v[20:23], v[32:35], v[80:83]
    buffer_load_dwordx4 v8, s[20:23], s83 offen offset:64 lds
    v_mfma_f32_16x16x32_bf16 v[84:87], a[64:67], v[20:23], v[84:87]
    v_sin_f32 v96, v92
    v_sin_f32 v97, v93
    v_mfma_f32_16x16x32_bf16 v[88:91], a[64:67], a[64:67], v[88:91]
    v_fmamk_f32 v98, v5, 0x40000000, v4
    s_add_u32 m0, s55, 104320
    s_and_b32 s6, s6, 7
    s_waitcnt lgkmcnt(4)
    v_mfma_f32_16x16x32_bf16 v[48:51], a[72:75], v[36:39], v[48:51]
    buffer_load_dwordx4 v10, s[20:23], s83 offen offset:128 lds
    v_mfma_f32_16x16x32_bf16 v[60:63], a[76:79], v[36:39], v[60:63]
    v_fmamk_f32 v99, v5, 0x40400000, v4
    v_cvt_pk_bf16_f32 v220, v94, v95
    v_cvt_pk_bf16_f32 v228, v96, v97
    v_mfma_f32_16x16x32_bf16 v[72:75], v[20:23], v[36:39], v[72:75]
    v_cos_f32 v100, v98
    s_waitcnt vmcnt(8)
    s_waitcnt lgkmcnt(0)
    s_barrier
    ds_read_b128 a[80:83], v11 offset:40960
    s_add_u32 m0, s76, 57344
    s_add_u32 s74, s74, 128
    s_and_b32 s74, s74, 0xfffffbff
    buffer_load_dwordx4 v18, s[8:11], s74 offen lds
    s_add_u32 m0, s76, 61440
    v_mfma_f32_16x16x32_bf16 v[52:55], a[72:75], v[40:43], v[52:55]
    buffer_load_dwordx4 v19, s[8:11], s74 offen lds
    ds_read_b64_tr_b16 v[24:25], v15 offset:12288
    v_mfma_f32_16x16x32_bf16 v[64:67], a[76:79], v[40:43], v[64:67]
    ds_read_b128 a[84:87], v13 offset:40960
    v_cos_f32 v101, v99
    s_mul_i32 s75, s49, 172
    s_mul_i32 s83, s6, 176128
    s_add_u32 m0, s55, 65536
    s_add_u32 s83, s83, s75
    v_mfma_f32_16x16x32_bf16 v[76:79], v[20:23], v[40:43], v[76:79]
    buffer_load_dwordx4 v8, s[20:23], s83 offen lds
    ds_read_b64_tr_b16 v[26:27], v15 offset:12544
    v_mfma_f32_16x16x32_bf16 v[56:59], a[72:75], v[44:47], v[56:59]
    ds_read_b64_tr_b16 v[28:29], v16 offset:12288
    v_sin_f32 v102, v98
    s_add_u32 m0, s55, 66496
    s_add_u32 s6, s6, 1
    v_mfma_f32_16x16x32_bf16 v[68:71], a[76:79], v[44:47], v[68:71]
    buffer_load_dwordx4 v8, s[20:23], s83 offen offset:64 lds
    ds_read_b64_tr_b16 v[30:31], v16 offset:12544
    v_mfma_f32_16x16x32_bf16 v[80:83], v[20:23], v[44:47], v[80:83]
    ds_read_b64_tr_b16 v[32:33], v17 offset:12288
    v_sin_f32 v103, v99
    v_mfma_f32_16x16x32_bf16 v[84:87], a[72:75], v[20:23], v[84:87]
    ds_read_b64_tr_b16 v[34:35], v17 offset:12544
    v_fmamk_f32 v92, v5, 0x40800000, v4
    v_fmamk_f32 v93, v5, 0x40a00000, v4
    s_add_u32 m0, s55, 67456
    s_and_b32 s6, s6, 7
    v_mfma_f32_16x16x32_bf16 v[88:91], a[72:75], a[72:75], v[88:91]
    buffer_load_dwordx4 v9, s[20:23], s83 offen offset:128 lds
    s_waitcnt lgkmcnt(4)
    v_mfma_f32_16x16x32_bf16 v[48:51], a[80:83], v[24:27], v[48:51]
    ds_read_b128 a[88:91], v12 offset:40960
    v_mfma_f32_16x16x32_bf16 v[60:63], a[84:87], v[24:27], v[60:63]
    ds_read_b64_tr_b16 v[36:37], v15 offset:18432
    v_cvt_pk_bf16_f32 v221, v100, v101
    v_mfma_f32_16x16x32_bf16 v[72:75], v[20:23], v[24:27], v[72:75]
    ds_read_b128 a[92:95], v14 offset:40960
    s_waitcnt lgkmcnt(5)
    v_mfma_f32_16x16x32_bf16 v[52:55], a[80:83], v[28:31], v[52:55]
    ds_read_b64_tr_b16 v[38:39], v15 offset:18688
    v_cvt_pk_bf16_f32 v229, v102, v103
    v_mfma_f32_16x16x32_bf16 v[64:67], a[84:87], v[28:31], v[64:67]
    ds_read_b64_tr_b16 v[40:41], v16 offset:18432
    v_mfma_f32_16x16x32_bf16 v[76:79], v[20:23], v[28:31], v[76:79]
    ds_read_b64_tr_b16 v[42:43], v16 offset:18688
    s_waitcnt lgkmcnt(6)
    v_mfma_f32_16x16x32_bf16 v[56:59], a[80:83], v[32:35], v[56:59]
    ds_read_b64_tr_b16 v[44:45], v17 offset:18432
    v_mfma_f32_16x16x32_bf16 v[68:71], a[84:87], v[32:35], v[68:71]
    ds_read_b64_tr_b16 v[46:47], v17 offset:18688
    v_mfma_f32_16x16x32_bf16 v[80:83], v[20:23], v[32:35], v[80:83]
    v_cos_f32 v94, v92
    v_mfma_f32_16x16x32_bf16 v[84:87], a[80:83], v[20:23], v[84:87]
    v_cos_f32 v95, v93
    v_mfma_f32_16x16x32_bf16 v[88:91], a[80:83], a[80:83], v[88:91]
    v_sin_f32 v96, v92
    s_waitcnt lgkmcnt(4)
    v_mfma_f32_16x16x32_bf16 v[48:51], a[88:91], v[36:39], v[48:51]
    v_sin_f32 v97, v93
    v_mfma_f32_16x16x32_bf16 v[60:63], a[92:95], v[36:39], v[60:63]
    v_fmamk_f32 v98, v5, 0x40c00000, v4
    v_fmamk_f32 v99, v5, 0x40e00000, v4
    v_mfma_f32_16x16x32_bf16 v[72:75], v[20:23], v[36:39], v[72:75]
    v_cvt_pk_bf16_f32 v222, v94, v95
    v_cvt_pk_bf16_f32 v230, v96, v97
    v_cos_f32 v100, v98
    s_waitcnt vmcnt(8)
    s_waitcnt lgkmcnt(0)
    s_barrier
    ds_read_b128 a[96:99], v11 offset:49152
    s_mul_i32 s83, s6, 176128
    s_add_u32 m0, s55, 77824
    s_add_u32 s83, s83, s75
    v_mfma_f32_16x16x32_bf16 v[52:55], a[88:91], v[40:43], v[52:55]
    buffer_load_dwordx4 v8, s[20:23], s83 offen lds
    ds_read_b64_tr_b16 v[24:25], v15 offset:24576
    v_mfma_f32_16x16x32_bf16 v[64:67], a[92:95], v[40:43], v[64:67]
    ds_read_b128 a[100:103], v13 offset:49152
    v_cos_f32 v101, v99
    v_mfma_f32_16x16x32_bf16 v[76:79], v[20:23], v[40:43], v[76:79]
    ds_read_b64_tr_b16 v[26:27], v15 offset:24832
    v_sin_f32 v102, v98
    s_add_u32 m0, s55, 78784
    s_add_u32 s6, s6, 1
    v_mfma_f32_16x16x32_bf16 v[56:59], a[88:91], v[44:47], v[56:59]
    buffer_load_dwordx4 v8, s[20:23], s83 offen offset:64 lds
    ds_read_b64_tr_b16 v[28:29], v16 offset:24576
    v_mfma_f32_16x16x32_bf16 v[68:71], a[92:95], v[44:47], v[68:71]
    ds_read_b64_tr_b16 v[30:31], v16 offset:24832
    v_mfma_f32_16x16x32_bf16 v[80:83], v[20:23], v[44:47], v[80:83]
    ds_read_b64_tr_b16 v[32:33], v17 offset:24576
    v_sin_f32 v103, v99
    v_mfma_f32_16x16x32_bf16 v[84:87], a[88:91], v[20:23], v[84:87]
    ds_read_b64_tr_b16 v[34:35], v17 offset:24832
    v_cvt_pk_bf16_f32 v223, v100, v101
    v_cvt_pk_bf16_f32 v231, v102, v103
    s_add_u32 m0, s55, 79744
    s_and_b32 s6, s6, 7
    v_mfma_f32_16x16x32_bf16 v[88:91], a[88:91], a[88:91], v[88:91]
    buffer_load_dwordx4 v9, s[20:23], s83 offen offset:128 lds
    s_waitcnt lgkmcnt(4)
    v_mfma_f32_16x16x32_bf16 v[48:51], a[96:99], v[24:27], v[48:51]
    ds_read_b128 a[104:107], v12 offset:49152
    v_mfma_f32_16x16x32_bf16 v[60:63], a[100:103], v[24:27], v[60:63]
    ds_read_b64_tr_b16 v[36:37], v15 offset:30720
    v_xor_b32 v208, 0x80008000, v200
    v_mfma_f32_16x16x32_bf16 v[72:75], v[20:23], v[24:27], v[72:75]
    ds_read_b128 a[108:111], v14 offset:49152
    s_waitcnt lgkmcnt(5)
    v_mfma_f32_16x16x32_bf16 v[52:55], a[96:99], v[28:31], v[52:55]
    ds_read_b64_tr_b16 v[38:39], v15 offset:30976
    v_bfe_u32 v6, v0, 5, 1
    s_lshl_b32 s52, s50, 1
    v_add_u32 v6, s52, v6
    v_bfe_u32 v7, v0, 2, 3
    v_lshl_add_u32 v6, v6, 6, v7
    v_mul_u32_u24 v6, 514, v6
    v_and_b32 v7, 3, v0
    v_lshl_add_u32 v6, v7, 4, v6
    s_andn2_b32 s52, s48, 3
    s_lshl_b32 s52, s52, 1
    s_and_b32 s53, s48, 3
    s_lshl_b32 s53, s53, 9
    s_add_u32 s52, s52, s53
    s_mul_i32 s52, s52, 514
    s_lshl_b32 s53, s49, 6
    s_add_u32 s52, s52, s53
    s_add_u32 s52, s52, 2
    s_lshl_b32 s53, s50, 10
    s_add_u32 m0, s53, 128512
    s_nop 0
    buffer_load_dwordx4 v6, s[12:15], s52 offen lds
    v_mfma_f32_16x16x32_bf16 v[64:67], a[100:103], v[28:31], v[64:67]
    ds_read_b64_tr_b16 v[40:41], v16 offset:30720
    v_xor_b32 v232, 0x80008000, v224
    v_mfma_f32_16x16x32_bf16 v[76:79], v[20:23], v[28:31], v[76:79]
    ds_read_b64_tr_b16 v[42:43], v16 offset:30976
    v_xor_b32 v209, 0x80008000, v201
    s_waitcnt lgkmcnt(6)
    v_mfma_f32_16x16x32_bf16 v[56:59], a[96:99], v[32:35], v[56:59]
    ds_read_b64_tr_b16 v[44:45], v17 offset:30720
    v_xor_b32 v233, 0x80008000, v225
    v_mfma_f32_16x16x32_bf16 v[68:71], a[100:103], v[32:35], v[68:71]
    ds_read_b64_tr_b16 v[46:47], v17 offset:30976
    v_xor_b32 v210, 0x80008000, v202
    v_mfma_f32_16x16x32_bf16 v[80:83], v[20:23], v[32:35], v[80:83]
    v_xor_b32 v234, 0x80008000, v226
    v_xor_b32 v211, 0x80008000, v203
    v_mfma_f32_16x16x32_bf16 v[84:87], a[96:99], v[20:23], v[84:87]
    v_xor_b32 v235, 0x80008000, v227
    v_xor_b32 v212, 0x80008000, v204
    s_add_u32 m0, s53, 132608
    s_nop 0
    v_mfma_f32_16x16x32_bf16 v[88:91], a[96:99], a[96:99], v[88:91]
    buffer_load_dwordx4 v6, s[16:19], s52 offen lds
    s_waitcnt lgkmcnt(4)
    v_mfma_f32_16x16x32_bf16 v[48:51], a[104:107], v[36:39], v[48:51]
    v_xor_b32 v236, 0x80008000, v228
    v_xor_b32 v213, 0x80008000, v205
    v_mfma_f32_16x16x32_bf16 v[60:63], a[108:111], v[36:39], v[60:63]
    v_mfma_f32_16x16x32_bf16 v[72:75], v[20:23], v[36:39], v[72:75]
    s_waitcnt vmcnt(8)
    s_waitcnt lgkmcnt(0)
    s_barrier
    ds_read_b128 a[112:115], v11 offset:57344
    v_mfma_f32_16x16x32_bf16 v[52:55], a[104:107], v[40:43], v[52:55]
    ds_read_b64_tr_b16 v[24:25], v15 offset:36864
    v_xor_b32 v237, 0x80008000, v229
    v_mfma_f32_16x16x32_bf16 v[64:67], a[108:111], v[40:43], v[64:67]
    ds_read_b128 a[116:119], v13 offset:57344
    v_mfma_f32_16x16x32_bf16 v[76:79], v[20:23], v[40:43], v[76:79]
    ds_read_b64_tr_b16 v[26:27], v15 offset:37120
    v_xor_b32 v214, 0x80008000, v206
    v_mfma_f32_16x16x32_bf16 v[56:59], a[104:107], v[44:47], v[56:59]
    ds_read_b64_tr_b16 v[28:29], v16 offset:36864
    v_xor_b32 v238, 0x80008000, v230
    v_mfma_f32_16x16x32_bf16 v[68:71], a[108:111], v[44:47], v[68:71]
    ds_read_b64_tr_b16 v[30:31], v16 offset:37120
    v_xor_b32 v215, 0x80008000, v207
    v_mfma_f32_16x16x32_bf16 v[80:83], v[20:23], v[44:47], v[80:83]
    ds_read_b64_tr_b16 v[32:33], v17 offset:36864
    v_xor_b32 v239, 0x80008000, v231
    v_mfma_f32_16x16x32_bf16 v[84:87], a[104:107], v[20:23], v[84:87]
    ds_read_b64_tr_b16 v[34:35], v17 offset:37120
    v_mfma_f32_16x16x32_bf16 v[88:91], a[104:107], a[104:107], v[88:91]
    s_waitcnt lgkmcnt(4)
    v_mfma_f32_16x16x32_bf16 v[48:51], a[112:115], v[24:27], v[48:51]
    ds_read_b128 a[120:123], v12 offset:57344
    v_mfma_f32_16x16x32_bf16 v[60:63], a[116:119], v[24:27], v[60:63]
    ds_read_b64_tr_b16 v[36:37], v15 offset:43008
    v_and_b32 v3, 15, v0
    v_mfma_f32_16x16x32_bf16 v[72:75], v[20:23], v[24:27], v[72:75]
    ds_read_b128 a[124:127], v14 offset:57344
    s_waitcnt lgkmcnt(5)
    v_mfma_f32_16x16x32_bf16 v[52:55], a[112:115], v[28:31], v[52:55]
    ds_read_b64_tr_b16 v[38:39], v15 offset:43264
    v_bfe_u32 v2, v0, 4, 2
    v_mfma_f32_16x16x32_bf16 v[64:67], a[116:119], v[28:31], v[64:67]
    ds_read_b64_tr_b16 v[40:41], v16 offset:43008
    v_lshrrev_b32 v5, 2, v3
    v_mfma_f32_16x16x32_bf16 v[76:79], v[20:23], v[28:31], v[76:79]
    ds_read_b64_tr_b16 v[42:43], v16 offset:43264
    v_cmp_eq_u32 vcc, v2, v5
    s_waitcnt lgkmcnt(6)
    v_mfma_f32_16x16x32_bf16 v[56:59], a[112:115], v[32:35], v[56:59]
    ds_read_b64_tr_b16 v[44:45], v17 offset:43008
    s_lshl_b32 s52, s50, 6
    s_add_u32 s52, s52, 145920
    v_mfma_f32_16x16x32_bf16 v[68:71], a[116:119], v[32:35], v[68:71]
    ds_read_b64_tr_b16 v[46:47], v17 offset:43264
    v_lshl_add_u32 v5, v3, 2, s52
    v_mfma_f32_16x16x32_bf16 v[80:83], v[20:23], v[32:35], v[80:83]
    v_and_b32 v6, 63, v0
    v_lshlrev_b32 v6, 2, v6
    v_mfma_f32_16x16x32_bf16 v[84:87], a[112:115], v[20:23], v[84:87]
    v_add_u32 v6, 148480, v6
    v_cndmask_b32 v4, v6, v5, vcc
    v_mfma_f32_16x16x32_bf16 v[88:91], a[112:115], a[112:115], v[88:91]
    s_lshl_b32 s53, s50, 8
    v_lshl_add_u32 v5, v3, 4, s53
    s_waitcnt lgkmcnt(7)
    v_mfma_f32_16x16x32_bf16 v[84:87], a[120:123], v[20:23], v[84:87]
    v_mov_b32 v6, 1073741824
    v_cndmask_b32 v19, v6, v5, vcc
    v_mfma_f32_16x16x32_bf16 v[88:91], a[120:123], a[120:123], v[88:91]
    v_lshl_add_u32 v5, v2, 4, s52
    v_xor_b32 v6, 64, v5
    s_waitcnt lgkmcnt(4)
    v_mfma_f32_16x16x32_bf16 v[48:51], a[120:123], v[36:39], v[48:51]
    v_bfe_u32 v3, v0, 2, 2
    v_lshl_add_u32 v2, v2, 3, v3
    v_mfma_f32_16x16x32_bf16 v[60:63], a[124:127], v[36:39], v[60:63]
    v_mul_u32_u24 v2, 144, v2
    v_and_b32 v3, 3, v0
    v_mfma_f32_16x16x32_bf16 v[72:75], v[20:23], v[36:39], v[72:75]
    v_lshl_add_u32 v2, v3, 3, v2
    s_lshl_b32 s52, s50, 5
    s_add_u32 s52, s52, 114688
    v_add_u32 v18, s52, v2
    v_cndmask_b32 v1, v84, v85, s[56:57]
    v_cndmask_b32 v1, v1, v86, s[58:59]
    v_cndmask_b32 v1, v1, v87, s[60:61]
    v_cndmask_b32 v2, v88, v89, s[56:57]
    v_cndmask_b32 v2, v2, v90, s[58:59]
    s_waitcnt lgkmcnt(2)
    v_mfma_f32_16x16x32_bf16 v[52:55], a[120:123], v[40:43], v[52:55]
    v_cndmask_b32 v2, v2, v91, s[60:61]
    v_mov_b32 v7, 0x3727c5ac
    v_mul_f32 v1, 0x3b000000, v1
    v_mul_f32 v3, v1, v1
    v_mfma_f32_16x16x32_bf16 v[64:67], a[124:127], v[40:43], v[64:67]
    v_fmamk_f32 v2, v2, 0x3b000000, v7
    v_sub_f32 v2, v2, v3
    v_max_f32 v2, v2, v7
    v_rsq_f32 v3, v2
    v_mfma_f32_16x16x32_bf16 v[76:79], v[20:23], v[40:43], v[76:79]
    v_mul_f32 v2, v1, v3
    v_mov_b32 v1, v3
    ds_write_b32 v4, v1
    ds_write_b32 v4, v2 offset:256
    s_waitcnt lgkmcnt(0)
    s_barrier
    ds_read_b128 v[92:95], v5
    ds_read_b128 v[100:103], v5 offset:256
    ds_read_b128 v[96:99], v6
    ds_read_b128 v[104:107], v6 offset:256
    v_mfma_f32_16x16x32_bf16 v[56:59], a[120:123], v[44:47], v[56:59]
    v_mfma_f32_16x16x32_bf16 v[68:71], a[124:127], v[44:47], v[68:71]
    v_mfma_f32_16x16x32_bf16 v[80:83], v[20:23], v[44:47], v[80:83]
    s_add_u32 s1, s7, 512
    s_and_b32 s1, s1, 1023
    s_add_u32 s1, s1, s77
    s_add_u32 m0, s68, 0
    s_nop 0
    buffer_load_dwordx4 v108, s[24:27], s1 offen lds
    v_mov_b32 v2, 0xc0135761
    v_mov_b32 v3, v2
    s_waitcnt lgkmcnt(2)
    v_pk_mul_f32 v[24:25], v[100:101], v[72:73]
    v_pk_mul_f32 v[26:27], v[102:103], v[72:73]
    s_waitcnt lgkmcnt(0)
    v_pk_mul_f32 v[36:37], v[104:105], v[72:73]
    v_pk_mul_f32 v[38:39], v[106:107], v[72:73]
    v_pk_fma_f32 v[24:25], v[48:49], v[92:93], v[24:25] neg_lo:[0,0,1] neg_hi:[0,0,1]
    v_pk_fma_f32 v[26:27], v[50:51], v[94:95], v[26:27] neg_lo:[0,0,1] neg_hi:[0,0,1]
    v_pk_fma_f32 v[36:37], v[60:61], v[96:97], v[36:37] neg_lo:[0,0,1] neg_hi:[0,0,1]
    v_pk_fma_f32 v[38:39], v[62:63], v[98:99], v[38:39] neg_lo:[0,0,1] neg_hi:[0,0,1]
    v_pk_mul_f32 v[28:29], v[24:25], v[24:25]
    v_pk_mul_f32 v[30:31], v[26:27], v[26:27]
    v_pk_mul_f32 v[40:41], v[36:37], v[36:37]
    v_pk_mul_f32 v[42:43], v[38:39], v[38:39]
    v_pk_fma_f32 v[28:29], v[28:29], s[64:65], v[2:3]
    v_pk_fma_f32 v[30:31], v[30:31], s[64:65], v[2:3]
    v_pk_fma_f32 v[40:41], v[40:41], s[64:65], v[2:3]
    v_pk_fma_f32 v[42:43], v[42:43], s[64:65], v[2:3]
    v_pk_mul_f32 v[28:29], v[28:29], v[24:25]
    v_pk_mul_f32 v[30:31], v[30:31], v[26:27]
    v_pk_mul_f32 v[40:41], v[40:41], v[36:37]
    v_pk_mul_f32 v[42:43], v[42:43], v[38:39]
    v_exp_f32 v32, v28
    v_exp_f32 v33, v29
    buffer_load_dwordx4 v109, s[24:27], s1 offen offset:1024 lds
    v_exp_f32 v34, v30
    v_exp_f32 v35, v31
    v_exp_f32 v44, v40
    v_exp_f32 v45, v41
    v_exp_f32 v46, v42
    v_exp_f32 v47, v43
    v_pk_add_f32 v[32:33], v[32:33], s[66:67]
    v_pk_add_f32 v[34:35], v[34:35], s[66:67]
    v_pk_add_f32 v[44:45], v[44:45], s[66:67]
    v_pk_add_f32 v[46:47], v[46:47], s[66:67]
    v_rcp_f32 v32, v32
    v_rcp_f32 v33, v33
    v_rcp_f32 v34, v34
    v_rcp_f32 v35, v35
    buffer_load_dwordx4 v110, s[24:27], s1 offen offset:2048 lds
    v_rcp_f32 v44, v44
    v_rcp_f32 v45, v45
    v_rcp_f32 v46, v46
    v_rcp_f32 v47, v47
    v_pk_mul_f32 v[24:25], v[24:25], v[32:33]
    v_pk_mul_f32 v[26:27], v[26:27], v[34:35]
    v_pk_mul_f32 v[36:37], v[36:37], v[44:45]
    v_pk_mul_f32 v[38:39], v[38:39], v[46:47]
    v_cvt_pk_bf16_f32 v48, v24, v25
    v_cvt_pk_bf16_f32 v49, v26, v27
    v_cvt_pk_bf16_f32 v60, v36, v37
    v_cvt_pk_bf16_f32 v61, v38, v39
    ds_write_b64 v124, v[48:49] offset:0
    v_pk_mul_f32 v[24:25], v[100:101], v[76:77]
    v_pk_mul_f32 v[26:27], v[102:103], v[76:77]
    v_pk_mul_f32 v[36:37], v[104:105], v[76:77]
    v_pk_mul_f32 v[38:39], v[106:107], v[76:77]
    v_pk_fma_f32 v[24:25], v[52:53], v[92:93], v[24:25] neg_lo:[0,0,1] neg_hi:[0,0,1]
    v_pk_fma_f32 v[26:27], v[54:55], v[94:95], v[26:27] neg_lo:[0,0,1] neg_hi:[0,0,1]
    v_pk_fma_f32 v[36:37], v[64:65], v[96:97], v[36:37] neg_lo:[0,0,1] neg_hi:[0,0,1]
    v_pk_fma_f32 v[38:39], v[66:67], v[98:99], v[38:39] neg_lo:[0,0,1] neg_hi:[0,0,1]
    buffer_load_dwordx4 v111, s[24:27], s1 offen offset:3072 lds
    ds_write_b64 v125, v[60:61] offset:0
    v_pk_mul_f32 v[28:29], v[24:25], v[24:25]
    v_pk_mul_f32 v[30:31], v[26:27], v[26:27]
    v_pk_mul_f32 v[40:41], v[36:37], v[36:37]
    v_pk_mul_f32 v[42:43], v[38:39], v[38:39]
    v_pk_fma_f32 v[28:29], v[28:29], s[64:65], v[2:3]
    v_pk_fma_f32 v[30:31], v[30:31], s[64:65], v[2:3]
    v_pk_fma_f32 v[40:41], v[40:41], s[64:65], v[2:3]
    v_pk_fma_f32 v[42:43], v[42:43], s[64:65], v[2:3]
    v_pk_mul_f32 v[28:29], v[28:29], v[24:25]
    v_pk_mul_f32 v[30:31], v[30:31], v[26:27]
    v_pk_mul_f32 v[40:41], v[40:41], v[36:37]
    v_pk_mul_f32 v[42:43], v[42:43], v[38:39]
    v_exp_f32 v32, v28
    v_exp_f32 v33, v29
    v_exp_f32 v34, v30
    v_exp_f32 v35, v31
    v_exp_f32 v44, v40
    v_exp_f32 v45, v41
    s_add_u32 m0, s68, 4096
    s_nop 0
    buffer_load_dwordx4 v112, s[24:27], s1 offen lds
    v_exp_f32 v46, v42
    v_exp_f32 v47, v43
    v_pk_add_f32 v[32:33], v[32:33], s[66:67]
    v_pk_add_f32 v[34:35], v[34:35], s[66:67]
    v_pk_add_f32 v[44:45], v[44:45], s[66:67]
    v_pk_add_f32 v[46:47], v[46:47], s[66:67]
    v_rcp_f32 v32, v32
    v_rcp_f32 v33, v33
    v_rcp_f32 v34, v34
    v_rcp_f32 v35, v35
    v_rcp_f32 v44, v44
    v_rcp_f32 v45, v45
    v_rcp_f32 v46, v46
    v_rcp_f32 v47, v47
    v_pk_mul_f32 v[24:25], v[24:25], v[32:33]
    buffer_load_dwordx4 v113, s[24:27], s1 offen offset:1024 lds
    v_pk_mul_f32 v[26:27], v[26:27], v[34:35]
    v_pk_mul_f32 v[36:37], v[36:37], v[44:45]
    v_pk_mul_f32 v[38:39], v[38:39], v[46:47]
    v_cvt_pk_bf16_f32 v52, v24, v25
    v_cvt_pk_bf16_f32 v53, v26, v27
    v_cvt_pk_bf16_f32 v64, v36, v37
    v_cvt_pk_bf16_f32 v65, v38, v39
    ds_write_b64 v124, v[52:53] offset:2304
    v_pk_mul_f32 v[24:25], v[100:101], v[80:81]
    v_pk_mul_f32 v[26:27], v[102:103], v[80:81]
    v_pk_mul_f32 v[36:37], v[104:105], v[80:81]
    v_pk_mul_f32 v[38:39], v[106:107], v[80:81]
    v_pk_fma_f32 v[24:25], v[56:57], v[92:93], v[24:25] neg_lo:[0,0,1] neg_hi:[0,0,1]
    v_pk_fma_f32 v[26:27], v[58:59], v[94:95], v[26:27] neg_lo:[0,0,1] neg_hi:[0,0,1]
    v_pk_fma_f32 v[36:37], v[68:69], v[96:97], v[36:37] neg_lo:[0,0,1] neg_hi:[0,0,1]
    v_pk_fma_f32 v[38:39], v[70:71], v[98:99], v[38:39] neg_lo:[0,0,1] neg_hi:[0,0,1]
    ds_write_b64 v125, v[64:65] offset:2304
    v_pk_mul_f32 v[28:29], v[24:25], v[24:25]
    v_pk_mul_f32 v[30:31], v[26:27], v[26:27]
    v_pk_mul_f32 v[40:41], v[36:37], v[36:37]
    v_pk_mul_f32 v[42:43], v[38:39], v[38:39]
    v_pk_fma_f32 v[28:29], v[28:29], s[64:65], v[2:3]
    v_pk_fma_f32 v[30:31], v[30:31], s[64:65], v[2:3]
    v_pk_fma_f32 v[40:41], v[40:41], s[64:65], v[2:3]
    v_pk_fma_f32 v[42:43], v[42:43], s[64:65], v[2:3]
    buffer_load_dwordx4 v114, s[24:27], s1 offen offset:2048 lds
    v_pk_mul_f32 v[28:29], v[28:29], v[24:25]
    v_pk_mul_f32 v[30:31], v[30:31], v[26:27]
    v_pk_mul_f32 v[40:41], v[40:41], v[36:37]
    v_pk_mul_f32 v[42:43], v[42:43], v[38:39]
    v_exp_f32 v32, v28
    v_exp_f32 v33, v29
    v_exp_f32 v34, v30
    v_exp_f32 v35, v31
    v_exp_f32 v44, v40
    v_exp_f32 v45, v41
    v_exp_f32 v46, v42
    v_exp_f32 v47, v43
    v_pk_add_f32 v[32:33], v[32:33], s[66:67]
    v_pk_add_f32 v[34:35], v[34:35], s[66:67]
    v_pk_add_f32 v[44:45], v[44:45], s[66:67]
    v_pk_add_f32 v[46:47], v[46:47], s[66:67]
    v_rcp_f32 v32, v32
    buffer_load_dwordx4 v115, s[24:27], s1 offen offset:3072 lds
    v_rcp_f32 v33, v33
    v_rcp_f32 v34, v34
    v_rcp_f32 v35, v35
    v_rcp_f32 v44, v44
    v_rcp_f32 v45, v45
    v_rcp_f32 v46, v46
    v_rcp_f32 v47, v47
    v_pk_mul_f32 v[24:25], v[24:25], v[32:33]
    v_pk_mul_f32 v[26:27], v[26:27], v[34:35]
    v_pk_mul_f32 v[36:37], v[36:37], v[44:45]
    v_pk_mul_f32 v[38:39], v[38:39], v[46:47]
    v_cvt_pk_bf16_f32 v56, v24, v25
    v_cvt_pk_bf16_f32 v57, v26, v27
    v_cvt_pk_bf16_f32 v68, v36, v37
    v_cvt_pk_bf16_f32 v69, v38, v39
    ds_write_b64 v124, v[56:57] offset:4608
    ds_write_b64 v125, v[68:69] offset:4608
    s_lshl_b32 s52, s48, 3
    s_add_u32 s52, s52, s49
    s_lshl_b32 s52, s52, 10
    s_add_u32 s52, s52, 65536
    s_waitcnt lgkmcnt(0)
    s_barrier
    ds_read_b64_tr_b16 v[24:25], v18 offset:0
    ds_read_b64_tr_b16 v[26:27], v18 offset:576
    ds_read_b64_tr_b16 v[28:29], v18 offset:4608
    ds_read_b64_tr_b16 v[30:31], v18 offset:5184
    ds_read_b64_tr_b16 v[32:33], v18 offset:9216
    ds_read_b64_tr_b16 v[34:35], v18 offset:9792
    v_mov_b32 v37, s51
    v_mov_b32 v39, s51
    s_waitcnt lgkmcnt(4)
    v_mfma_f32_16x16x32_bf16 v[84:87], v[24:27], v[20:23], 0
    v_mfma_f32_16x16x32_bf16 v[88:91], v[24:27], v[24:27], 0
    s_waitcnt lgkmcnt(2)
    v_mfma_f32_16x16x32_bf16 v[84:87], v[28:31], v[20:23], v[84:87]
    v_mfma_f32_16x16x32_bf16 v[88:91], v[28:31], v[28:31], v[88:91]
    s_waitcnt lgkmcnt(0)
    v_mfma_f32_16x16x32_bf16 v[84:87], v[32:35], v[20:23], v[84:87]
    v_mfma_f32_16x16x32_bf16 v[88:91], v[32:35], v[32:35], v[88:91]
    s_nop 6
    v_cndmask_b32 v36, v84, v85, s[56:57]
    v_cndmask_b32 v36, v36, v86, s[58:59]
    v_cndmask_b32 v36, v36, v87, s[60:61]
    v_cndmask_b32 v38, v88, v89, s[56:57]
    v_cndmask_b32 v38, v38, v90, s[58:59]
    v_cndmask_b32 v38, v38, v91, s[60:61]
    buffer_store_dwordx4 v[36:39], v19, s[40:43], s52 offen sc1
    v_mfma_f32_16x16x32_bf16 v[48:51], a[0:3], v[128:131], 0
    v_and_b32 v5, 31, v0
    s_lshl_b32 s54, s50, 3
    s_mul_i32 s83, s6, 176128
    s_add_u32 m0, s55, 90112
    s_add_u32 s83, s83, s75
    v_mfma_f32_16x16x32_bf16 v[52:55], a[0:3], v[132:135], 0
    buffer_load_dwordx4 v8, s[20:23], s83 offen lds
    v_mfma_f32_16x16x32_bf16 v[56:59], a[4:7], v[128:131], 0
    v_xor_b32 v5, s54, v5
    v_bfe_u32 v6, v5, 1, 3
    v_mfma_f32_16x16x32_bf16 v[60:63], a[4:7], v[132:135], 0
    v_bfe_u32 v11, v0, 5, 1
    v_xor_b32 v6, v6, v11
    v_mfma_f32_16x16x32_bf16 v[48:51], a[8:11], v[136:139], v[48:51]
    v_lshlrev_b32 v6, 4, v6
    v_lshl_add_u32 v5, v5, 7, v6
    v_mfma_f32_16x16x32_bf16 v[52:55], a[8:11], v[140:143], v[52:55]
    v_add_u32 v11, s68, v5
    s_add_u32 m0, s55, 91072
    s_add_u32 s6, s6, 1
    v_mfma_f32_16x16x32_bf16 v[56:59], a[12:15], v[136:139], v[56:59]
    buffer_load_dwordx4 v8, s[20:23], s83 offen offset:64 lds
    v_mfma_f32_16x16x32_bf16 v[60:63], a[12:15], v[140:143], v[60:63]
    v_xor_b32 v12, 32, v11
    v_mfma_f32_16x16x32_bf16 v[48:51], a[16:19], v[144:147], v[48:51]
    v_xor_b32 v13, 64, v11
    v_mfma_f32_16x16x32_bf16 v[52:55], a[16:19], v[148:151], v[52:55]
    v_xor_b32 v14, 96, v11
    s_add_u32 m0, s55, 92032
    s_and_b32 s6, s6, 7
    v_mfma_f32_16x16x32_bf16 v[56:59], a[20:23], v[144:147], v[56:59]
    buffer_load_dwordx4 v9, s[20:23], s83 offen offset:128 lds
    v_mfma_f32_16x16x32_bf16 v[60:63], a[20:23], v[148:151], v[60:63]
    v_and_b32 v18, 63, v0
    v_mfma_f32_16x16x32_bf16 v[48:51], a[24:27], v[152:155], v[48:51]
    v_lshlrev_b32 v18, 4, v18
    v_mfma_f32_16x16x32_bf16 v[52:55], a[24:27], v[156:159], v[52:55]
    s_lshl_b32 s80, s48, 13
    s_lshl_b32 s54, s50, 11
    s_add_u32 s80, s80, s54
    s_add_u32 s80, s80, 65536
    v_mfma_f32_16x16x32_bf16 v[56:59], a[28:31], v[152:155], v[56:59]
    v_and_b32 v2, 1, v0
    v_lshlrev_b32 v2, 31, v2
    s_mul_i32 s83, s6, 176128
    s_add_u32 m0, s55, 102400
    s_add_u32 s83, s83, s75
    v_mfma_f32_16x16x32_bf16 v[60:63], a[28:31], v[156:159], v[60:63]
    buffer_load_dwordx4 v8, s[20:23], s83 offen lds
    v_mfma_f32_16x16x32_bf16 v[48:51], a[32:35], v[160:163], v[48:51]
    v_xor_b32 v2, 0xbf800000, v2
    v_mfma_f32_16x16x32_bf16 v[52:55], a[32:35], v[164:167], v[52:55]
    v_and_b32 v6, 15, v0
    v_mfma_f32_16x16x32_bf16 v[56:59], a[36:39], v[160:163], v[56:59]
    v_mul_u32_u24 v6, 288, v6
    s_add_u32 m0, s55, 103360
    s_add_u32 s6, s6, 1
    v_mfma_f32_16x16x32_bf16 v[60:63], a[36:39], v[164:167], v[60:63]
    buffer_load_dwordx4 v8, s[20:23], s83 offen offset:64 lds
    v_mfma_f32_16x16x32_bf16 v[48:51], a[40:43], v[168:171], v[48:51]
    v_bfe_u32 v7, v0, 4, 2
    v_mfma_f32_16x16x32_bf16 v[52:55], a[40:43], v[172:175], v[52:55]
    v_lshl_add_u32 v6, v7, 3, v6
    v_mfma_f32_16x16x32_bf16 v[56:59], a[44:47], v[168:171], v[56:59]
    s_mul_i32 s52, s73, 4608
    s_lshl_b32 s53, s50, 5
    s_add_u32 s52, s52, s53
    v_mfma_f32_16x16x32_bf16 v[60:63], a[44:47], v[172:175], v[60:63]
    s_add_u32 s52, s52, 136704
    s_lshl_b32 s53, s73, 6
    s_sub_u32 s53, 32, s53
    v_add_u32 v6, s52, v6
    s_add_u32 m0, s55, 104320
    s_and_b32 s6, s6, 7
    v_mfma_f32_16x16x32_bf16 v[48:51], a[48:51], v[176:179], v[48:51]
    buffer_load_dwordx4 v9, s[20:23], s83 offen offset:128 lds
    v_mfma_f32_16x16x32_bf16 v[52:55], a[48:51], v[180:183], v[52:55]
    v_add_u32 v7, s53, v6
    v_mfma_f32_16x16x32_bf16 v[56:59], a[52:55], v[176:179], v[56:59]
    v_bfe_u32 v88, v0, 2, 2
    v_mfma_f32_16x16x32_bf16 v[60:63], a[52:55], v[180:183], v[60:63]
    v_bfe_u32 v89, v0, 4, 2
    v_mfma_f32_16x16x32_bf16 v[48:51], a[56:59], v[184:187], v[48:51]
    v_lshlrev_b32 v88, 9, v88
    s_add_u32 s1, s7, 640
    s_and_b32 s1, s1, 1023
    s_add_u32 s1, s1, s77
    s_add_u32 m0, s68, 32768
    v_mfma_f32_16x16x32_bf16 v[52:55], a[56:59], v[188:191], v[52:55]
    buffer_load_dwordx4 v108, s[24:27], s1 offen lds
    v_mfma_f32_16x16x32_bf16 v[56:59], a[60:63], v[184:187], v[56:59]
    v_lshl_add_u32 v88, v89, 7, v88
    v_mfma_f32_16x16x32_bf16 v[60:63], a[60:63], v[188:191], v[60:63]
    v_and_b32 v90, 3, v0
    v_mfma_f32_16x16x32_bf16 v[64:67], a[64:67], v[128:131], 0
    v_lshl_add_u32 v88, v90, 3, v88
    v_mfma_f32_16x16x32_bf16 v[68:71], a[64:67], v[132:135], 0
    buffer_load_dwordx4 v109, s[24:27], s1 offen offset:1024 lds
    v_mfma_f32_16x16x32_bf16 v[72:75], a[68:71], v[128:131], 0
    s_lshl_b32 s52, s73, 12
    s_lshl_b32 s53, s72, 5
    s_add_u32 s52, s52, s53
    s_add_u32 s52, s52, 128512
    v_add_u32 v88, s52, v88
    v_mfma_f32_16x16x32_bf16 v[76:79], a[68:71], v[132:135], 0
    v_and_b32 v91, 7, v0
    v_mfma_f32_16x16x32_bf16 v[64:67], a[72:75], v[136:139], v[64:67]
    v_lshlrev_b32 v89, 1, v89
    v_mfma_f32_16x16x32_bf16 v[68:71], a[72:75], v[140:143], v[68:71]
    v_xor_b32 v89, v89, v91
    v_mfma_f32_16x16x32_bf16 v[72:75], a[76:79], v[136:139], v[72:75]
    buffer_load_dwordx4 v110, s[24:27], s1 offen offset:2048 lds
    v_mfma_f32_16x16x32_bf16 v[76:79], a[76:79], v[140:143], v[76:79]
    v_and_b32 v90, 15, v0
    v_mfma_f32_16x16x32_bf16 v[64:67], a[80:83], v[144:147], v[64:67]
    v_lshlrev_b32 v90, 7, v90
    v_mfma_f32_16x16x32_bf16 v[68:71], a[80:83], v[148:151], v[68:71]
    v_lshl_add_u32 v90, v89, 4, v90
    v_mfma_f32_16x16x32_bf16 v[72:75], a[84:87], v[144:147], v[72:75]
    buffer_load_dwordx4 v111, s[24:27], s1 offen offset:3072 lds
    v_mfma_f32_16x16x32_bf16 v[76:79], a[84:87], v[148:151], v[76:79]
    s_lshl_b32 s52, s50, 11
    s_add_u32 s52, s52, 128512
    v_add_u32 v90, s52, v90
    v_mfma_f32_16x16x32_bf16 v[64:67], a[88:91], v[152:155], v[64:67]
    v_xor_b32 v89, 16, v90
    v_mfma_f32_16x16x32_bf16 v[68:71], a[88:91], v[156:159], v[68:71]
    v_and_b32 v91, 63, v0
    v_mfma_f32_16x16x32_bf16 v[72:75], a[92:95], v[152:155], v[72:75]
    v_lshl_add_u32 v91, v91, 4, s52
    s_waitcnt vmcnt(11)
    s_add_u32 m0, s68, 36864
    v_mfma_f32_16x16x32_bf16 v[76:79], a[92:95], v[156:159], v[76:79]
    buffer_load_dwordx4 v112, s[24:27], s1 offen lds
    v_mfma_f32_16x16x32_bf16 v[64:67], a[96:99], v[160:163], v[64:67]
    ds_read_b128 a[128:131], v11 offset:0
    v_mfma_f32_16x16x32_bf16 v[68:71], a[96:99], v[164:167], v[68:71]
    ds_read_b128 a[132:135], v11 offset:4096
    v_mfma_f32_16x16x32_bf16 v[72:75], a[100:103], v[160:163], v[72:75]
    v_mfma_f32_16x16x32_bf16 v[76:79], a[100:103], v[164:167], v[76:79]
    buffer_load_dwordx4 v113, s[24:27], s1 offen offset:1024 lds
    v_mfma_f32_16x16x32_bf16 v[64:67], a[104:107], v[168:171], v[64:67]
    ds_read_b128 a[136:139], v12 offset:0
    v_mfma_f32_16x16x32_bf16 v[68:71], a[104:107], v[172:175], v[68:71]
    ds_read_b128 a[140:143], v12 offset:4096
    v_mfma_f32_16x16x32_bf16 v[72:75], a[108:111], v[168:171], v[72:75]
    ds_read_b128 a[144:147], v13 offset:0
    v_mfma_f32_16x16x32_bf16 v[76:79], a[108:111], v[172:175], v[76:79]
    v_mfma_f32_16x16x32_bf16 v[64:67], a[112:115], v[176:179], v[64:67]
    buffer_load_dwordx4 v114, s[24:27], s1 offen offset:2048 lds
    v_mfma_f32_16x16x32_bf16 v[68:71], a[112:115], v[180:183], v[68:71]
    ds_read_b128 a[148:151], v13 offset:4096
    v_mfma_f32_16x16x32_bf16 v[72:75], a[116:119], v[176:179], v[72:75]
    ds_read_b128 a[152:155], v14 offset:0
    v_mfma_f32_16x16x32_bf16 v[76:79], a[116:119], v[180:183], v[76:79]
    ds_read_b128 a[156:159], v14 offset:4096
    v_mfma_f32_16x16x32_bf16 v[64:67], a[120:123], v[184:187], v[64:67]
    v_mfma_f32_16x16x32_bf16 v[68:71], a[120:123], v[188:191], v[68:71]
    buffer_load_dwordx4 v115, s[24:27], s1 offen offset:3072 lds
    v_mfma_f32_16x16x32_bf16 v[72:75], a[124:127], v[184:187], v[72:75]
    v_mfma_f32_16x16x32_bf16 v[76:79], a[124:127], v[188:191], v[76:79]
    buffer_load_dwordx4 v[80:83], v18, s[40:43], s80 offen offset:0 sc1
    buffer_load_dwordx4 v[84:87], v18, s[40:43], s80 offen offset:1024 sc1
    s_waitcnt lgkmcnt(0)
    s_barrier
    ds_read_b64_tr_b16 v[24:25], v15 offset:0
    ds_read_b64_tr_b16 v[26:27], v15 offset:256
    ds_read_b64_tr_b16 v[28:29], v16 offset:0
    ds_read_b64_tr_b16 v[30:31], v16 offset:256
    ds_read_b64_tr_b16 v[32:33], v17 offset:0
    ds_read_b64_tr_b16 v[34:35], v17 offset:256
    s_waitcnt lgkmcnt(4)
    v_mfma_f32_16x16x32_bf16 v[128:131], a[0:3], v[24:27], 0
    ds_read_b64_tr_b16 v[36:37], v15 offset:6144
    ds_read_b64_tr_b16 v[176:177], v88 offset:0
    ds_read_b64_tr_b16 v[178:179], v88 offset:2048
    ds_read_b64_tr_b16 v[180:181], v88 offset:64
    ds_read_b64_tr_b16 v[182:183], v88 offset:2112
    v_fmac_f32 v48, v2, v64
    s_add_u32 s1, s7, 768
    s_and_b32 s1, s1, 1023
    s_add_u32 s1, s1, s77
    s_add_u32 m0, s68, 0
    v_mfma_f32_16x16x32_bf16 v[140:143], a[4:7], v[24:27], 0
    buffer_load_dwordx4 v108, s[24:27], s1 offen lds
    ds_read_b64_tr_b16 v[38:39], v15 offset:6400
    v_mfma_f32_16x16x32_bf16 v[152:155], v[20:23], v[24:27], 0
    ds_read_b64_tr_b16 v[40:41], v16 offset:6144
    v_fmac_f32 v49, v2, v65
    v_fmac_f32 v50, v2, v66
    v_fmac_f32 v51, v2, v67
    v_mul_f32 v48, v48, v92
    s_waitcnt lgkmcnt(9)
    v_mfma_f32_16x16x32_bf16 v[132:135], a[0:3], v[28:31], 0
    ds_read_b64_tr_b16 v[42:43], v16 offset:6400
    v_mul_f32 v49, v49, v93
    v_mul_f32 v50, v50, v94
    v_mul_f32 v51, v51, v95
    v_cvt_pk_bf16_f32 v64, v48, v49
    v_cvt_pk_bf16_f32 v65, v50, v51
    v_mfma_f32_16x16x32_bf16 v[144:147], a[4:7], v[28:31], 0
    buffer_load_dwordx4 v109, s[24:27], s1 offen offset:1024 lds
    ds_read_b64_tr_b16 v[44:45], v17 offset:6144
    v_mfma_f32_16x16x32_bf16 v[156:159], v[20:23], v[28:31], 0
    ds_read_b64_tr_b16 v[46:47], v17 offset:6400
    ds_write_b64 v6, v[64:65] offset:0
    v_fmac_f32 v52, v2, v68
    v_fmac_f32 v53, v2, v69
    s_waitcnt lgkmcnt(11)
    v_mfma_f32_16x16x32_bf16 v[136:139], a[0:3], v[32:35], 0
    v_fmac_f32 v54, v2, v70
    v_fmac_f32 v55, v2, v71
    v_mul_f32 v52, v52, v92
    v_mul_f32 v53, v53, v93
    v_mul_f32 v54, v54, v94
    v_mul_f32 v55, v55, v95
    v_cvt_pk_bf16_f32 v68, v52, v53
    v_cvt_pk_bf16_f32 v69, v54, v55
    ds_write_b64 v6, v[68:69] offset:144
    v_mfma_f32_16x16x32_bf16 v[148:151], a[4:7], v[32:35], 0
    buffer_load_dwordx4 v110, s[24:27], s1 offen offset:2048 lds
    v_mfma_f32_16x16x32_bf16 v[160:163], v[20:23], v[32:35], 0
    v_fmac_f32 v56, v2, v72
    v_fmac_f32 v57, v2, v73
    v_fmac_f32 v58, v2, v74
    v_fmac_f32 v59, v2, v75
    v_mul_f32 v56, v56, v96
    v_mul_f32 v57, v57, v97
    v_mul_f32 v58, v58, v98
    v_mul_f32 v59, v59, v99
    s_waitcnt lgkmcnt(6)
    v_mfma_f32_16x16x32_bf16 v[128:131], a[8:11], v[36:39], v[128:131]
    v_cvt_pk_bf16_f32 v72, v56, v57
    v_cvt_pk_bf16_f32 v73, v58, v59
    ds_write_b64 v7, v[72:73] offset:0
    v_fmac_f32 v60, v2, v76
    v_fmac_f32 v61, v2, v77
    v_fmac_f32 v62, v2, v78
    v_fmac_f32 v63, v2, v79
    v_mul_f32 v60, v60, v96
    v_mfma_f32_16x16x32_bf16 v[140:143], a[12:15], v[36:39], v[140:143]
    buffer_load_dwordx4 v111, s[24:27], s1 offen offset:3072 lds
    v_mfma_f32_16x16x32_bf16 v[152:155], v[20:23], v[36:39], v[152:155]
    v_mul_f32 v61, v61, v97
    v_mul_f32 v62, v62, v98
    v_mul_f32 v63, v63, v99
    v_cvt_pk_bf16_f32 v76, v60, v61
    v_cvt_pk_bf16_f32 v77, v62, v63
    ds_write_b64 v7, v[76:77] offset:144
    v_add_u32 v1, 136704, v127
    v_add_u32 v3, 114688, v127
    s_waitcnt lgkmcnt(0)
    s_barrier
    ds_read_b64_tr_b16 v[24:25], v15 offset:12288
    s_add_u32 s1, s7, 768
    s_and_b32 s1, s1, 1023
    s_add_u32 s1, s1, s77
    s_add_u32 m0, s68, 4096
    s_nop 0
    buffer_load_dwordx4 v112, s[24:27], s1 offen lds
    v_mfma_f32_16x16x32_bf16 v[132:135], a[8:11], v[40:43], v[132:135]
    buffer_load_dwordx4 v113, s[24:27], s1 offen offset:1024 lds
    ds_read_b64_tr_b16 v[26:27], v15 offset:12544
    v_mfma_f32_16x16x32_bf16 v[144:147], a[12:15], v[40:43], v[144:147]
    ds_read_b64_tr_b16 v[28:29], v16 offset:12288
    ds_read_b128 v[56:59], v1 offset:0
    ds_read_b128 v[60:63], v1 offset:4608
    v_mfma_f32_16x16x32_bf16 v[156:159], v[20:23], v[40:43], v[156:159]
    buffer_load_dwordx4 v114, s[24:27], s1 offen offset:2048 lds
    ds_read_b64_tr_b16 v[30:31], v16 offset:12544
    v_mfma_f32_16x16x32_bf16 v[136:139], a[8:11], v[44:47], v[136:139]
    ds_read_b64_tr_b16 v[32:33], v17 offset:12288
    ds_read_b128 v[164:167], v3 offset:0
    v_mfma_f32_16x16x32_bf16 v[148:151], a[12:15], v[44:47], v[148:151]
    ds_read_b64_tr_b16 v[34:35], v17 offset:12544
    ds_read_b128 v[168:171], v3 offset:4608
    ds_read_b128 v[172:175], v3 offset:9216
    v_mfma_f32_16x16x32_bf16 v[160:163], v[20:23], v[44:47], v[160:163]
    buffer_load_dwordx4 v115, s[24:27], s1 offen offset:3072 lds
    s_waitcnt lgkmcnt(9)
    v_mfma_f32_16x16x32_bf16 v[128:131], a[16:19], v[24:27], v[128:131]
    ds_read_b64_tr_b16 v[36:37], v15 offset:18432
    s_lshl_b32 s52, s49, 18
    s_lshl_b32 s53, s48, 7
    s_add_u32 s52, s52, s53
    s_add_u32 s52, s52, 1048576
    s_add_u32 s53, s52, 131072
    s_waitcnt lgkmcnt(8)
    buffer_store_dwordx4 v[56:59], v126, s[40:43], s52 offen sc1
    s_mul_i32 s83, s6, 176128
    s_add_u32 m0, s55, 65536
    s_add_u32 s83, s83, s75
    v_mfma_f32_16x16x32_bf16 v[140:143], a[20:23], v[24:27], v[140:143]
    buffer_load_dwordx4 v8, s[20:23], s83 offen lds
    ds_read_b64_tr_b16 v[38:39], v15 offset:18688
    v_mfma_f32_16x16x32_bf16 v[152:155], v[20:23], v[24:27], v[152:155]
    ds_read_b64_tr_b16 v[40:41], v16 offset:18432
    s_waitcnt lgkmcnt(9)
    buffer_store_dwordx4 v[60:63], v126, s[40:43], s53 offen sc1
    s_waitcnt lgkmcnt(8)
    v_mfma_f32_16x16x32_bf16 v[132:135], a[16:19], v[28:31], v[132:135]
    ds_read_b64_tr_b16 v[42:43], v16 offset:18688
    v_and_b32 v68, 63, v0
    v_lshlrev_b32 v70, 2, v68
    v_mfma_f32_16x16x32_bf16 v[144:147], a[20:23], v[28:31], v[144:147]
    ds_read_b64_tr_b16 v[44:45], v17 offset:18432
    v_lshlrev_b32 v68, 3, v68
    v_add_u32 v68, 146432, v68
    s_lshl_b32 s54, s50, 9
    v_add_u32 v69, s54, v68
    v_mfma_f32_16x16x32_bf16 v[156:159], v[20:23], v[28:31], v[156:159]
    ds_read_b64_tr_b16 v[46:47], v17 offset:18688
    ds_write_b128 v90, v[176:179]
    s_add_u32 m0, s55, 66496
    s_add_u32 s6, s6, 1
    s_waitcnt lgkmcnt(9)
    v_mfma_f32_16x16x32_bf16 v[136:139], a[16:19], v[32:35], v[136:139]
    buffer_load_dwordx4 v8, s[20:23], s83 offen offset:64 lds
    v_mfma_f32_16x16x32_bf16 v[148:151], a[20:23], v[32:35], v[148:151]
    ds_write_b128 v89, v[180:183]
    v_mfma_f32_16x16x32_bf16 v[160:163], v[20:23], v[32:35], v[160:163]
    ds_read_b128 v[72:75], v91 offset:0
    ds_read_b128 v[76:79], v91 offset:1024
    v_bfe_u32 v88, v0, 3, 3
    v_and_b32 v89, 7, v0
    v_xor_b32 v89, v89, v88
    v_lshlrev_b32 v89, 4, v89
    v_lshl_add_u32 v88, v88, 13, v89
    s_add_u32 m0, s55, 67456
    s_and_b32 s6, s6, 7
    s_waitcnt lgkmcnt(8)
    v_mfma_f32_16x16x32_bf16 v[128:131], a[24:27], v[36:39], v[128:131]
    buffer_load_dwordx4 v9, s[20:23], s83 offen offset:128 lds
    v_mfma_f32_16x16x32_bf16 v[140:143], a[28:31], v[36:39], v[140:143]
    s_waitcnt vmcnt(14)
    v_cmp_ne_u32 vcc, s51, v81
    v_cmp_ne_u32 s[100:101], s51, v83
    s_nop 0
    s_or_b64 vcc, vcc, s[100:101]
    s_waitcnt vmcnt(13)
    v_cmp_ne_u32 s[100:101], s51, v85
    s_nop 0
    s_or_b64 vcc, vcc, s[100:101]
    v_cmp_ne_u32 s[100:101], s51, v87
    s_nop 0
    s_or_b64 vcc, vcc, s[100:101]
    s_cbranch_scc0 L_ok0
    s_mov_b32 s78, 0x200000
L_poll0:
    s_sleep 1
    buffer_load_dwordx4 v[80:83], v18, s[40:43], s80 offen offset:0 sc1
    buffer_load_dwordx4 v[84:87], v18, s[40:43], s80 offen offset:1024 sc1
    s_sub_u32 s78, s78, 1
    s_cbranch_scc1 L_end
    s_waitcnt vmcnt(0)
    v_cmp_ne_u32 vcc, s51, v81
    v_cmp_ne_u32 s[100:101], s51, v83
    s_nop 0
    s_or_b64 vcc, vcc, s[100:101]
    v_cmp_ne_u32 s[100:101], s51, v85
    s_nop 0
    s_or_b64 vcc, vcc, s[100:101]
    v_cmp_ne_u32 s[100:101], s51, v87
    s_nop 0
    s_or_b64 vcc, vcc, s[100:101]
    s_cbranch_scc1 L_poll0
L_ok0:
    v_add_f32 v80, v80, v84
    v_add_f32 v81, v82, v86
    v_mfma_f32_16x16x32_bf16 v[152:155], v[20:23], v[36:39], v[152:155]
    ds_write_b64 v69, v[80:81]
    ds_read_b128 a[160:163], v11 offset:32768
    ds_read_b128 a[164:167], v11 offset:36864
    ds_read_b128 a[168:171], v12 offset:32768
    ds_read_b128 a[172:175], v12 offset:36864
    s_waitcnt lgkmcnt(0)
    s_barrier
    ds_read_b64_tr_b16 v[24:25], v15 offset:24576
    ds_read_b64 v[80:81], v68 offset:0
    ds_read_b64 v[82:83], v68 offset:512
    ds_read_b64 v[84:85], v68 offset:1024
    v_mfma_f32_16x16x32_bf16 v[132:135], a[24:27], v[40:43], v[132:135]
    ds_read_b64_tr_b16 v[26:27], v15 offset:24832
    ds_read_b64 v[86:87], v68 offset:1536
    s_add_u32 s54, s54, 128512
    v_add_u32 v70, s54, v70
    v_and_b32 v69, 7, v0
    v_mfma_f32_16x16x32_bf16 v[144:147], a[28:31], v[40:43], v[144:147]
    ds_read_b64_tr_b16 v[28:29], v16 offset:24576
    v_lshl_add_u32 v69, v69, 5, s54
    s_lshl_b32 s80, s72, 17
    s_lshl_b32 s78, s73, 10
    s_add_u32 s80, s80, s78
    s_lshl_b32 s78, s49, 18
    s_add_u32 s80, s80, s78
    s_lshr_b32 s78, s48, 3
    s_lshl_b32 s78, s78, 11
    s_add_u32 s80, s80, s78
    s_and_b32 s78, s48, 3
    v_mfma_f32_16x16x32_bf16 v[156:159], v[20:23], v[40:43], v[156:159]
    ds_read_b64_tr_b16 v[30:31], v16 offset:24832
    s_lshl_b32 s78, s78, 8
    s_add_u32 s80, s80, s78
    s_and_b32 s78, s48, 4
    s_lshl_b32 s78, s78, 5
    s_add_u32 s80, s80, s78
    s_add_u32 s80, s80, 3145728
    s_add_u32 s78, s80, 65536
    v_mfma_f32_16x16x32_bf16 v[136:139], a[24:27], v[44:47], v[136:139]
    ds_read_b64_tr_b16 v[32:33], v17 offset:24576
    buffer_store_dwordx4 v[72:75], v88, s[40:43], s80 offen sc1
    v_mfma_f32_16x16x32_bf16 v[148:151], a[28:31], v[44:47], v[148:151]
    ds_read_b64_tr_b16 v[34:35], v17 offset:24832
    buffer_store_dwordx4 v[76:79], v88, s[40:43], s78 offen sc1
    v_mfma_f32_16x16x32_bf16 v[160:163], v[20:23], v[44:47], v[160:163]
    ds_read_b128 a[176:179], v13 offset:32768
    ds_read_b128 a[180:183], v13 offset:36864
    ds_read_b128 a[184:187], v14 offset:32768
    ds_read_b128 a[188:191], v14 offset:36864
    s_waitcnt lgkmcnt(9)
    v_mfma_f32_16x16x32_bf16 v[128:131], a[32:35], v[24:27], v[128:131]
    ds_read_b64_tr_b16 v[36:37], v15 offset:30720
    v_add_f32 v80, v80, v82
    v_add_f32 v81, v81, v83
    s_mul_i32 s83, s6, 176128
    s_add_u32 m0, s55, 77824
    s_add_u32 s83, s83, s75
    v_mfma_f32_16x16x32_bf16 v[140:143], a[36:39], v[24:27], v[140:143]
    buffer_load_dwordx4 v8, s[20:23], s83 offen lds
    ds_read_b64_tr_b16 v[38:39], v15 offset:30976
    v_mfma_f32_16x16x32_bf16 v[152:155], v[20:23], v[24:27], v[152:155]
    ds_read_b64_tr_b16 v[40:41], v16 offset:30720
    s_waitcnt lgkmcnt(11)
    v_add_f32 v84, v84, v86
    v_add_f32 v85, v85, v87
    s_waitcnt lgkmcnt(9)
    v_mfma_f32_16x16x32_bf16 v[132:135], a[32:35], v[28:31], v[132:135]
    ds_read_b64_tr_b16 v[42:43], v16 offset:30976
    v_add_f32 v80, v80, v84
    v_add_f32 v81, v81, v85
    v_mfma_f32_16x16x32_bf16 v[144:147], a[36:39], v[28:31], v[144:147]
    ds_read_b64_tr_b16 v[44:45], v17 offset:30720
    v_mov_b32 v83, 0x3727c5ac
    v_mfma_f32_16x16x32_bf16 v[156:159], v[20:23], v[28:31], v[156:159]
    ds_read_b64_tr_b16 v[46:47], v17 offset:30976
    v_mul_f32 v80, 0x3abe82fa, v80
    v_mul_f32 v82, v80, v80
    s_add_u32 m0, s55, 78784
    s_add_u32 s6, s6, 1
    s_waitcnt lgkmcnt(10)
    v_mfma_f32_16x16x32_bf16 v[136:139], a[32:35], v[32:35], v[136:139]
    buffer_load_dwordx4 v8, s[20:23], s83 offen offset:64 lds
    v_mfma_f32_16x16x32_bf16 v[148:151], a[36:39], v[32:35], v[148:151]
    v_fmamk_f32 v81, v81, 0x3abe82fa, v83
    v_sub_f32 v81, v81, v82
    v_max_f32 v81, v81, v83
    v_mfma_f32_16x16x32_bf16 v[160:163], v[20:23], v[32:35], v[160:163]
    v_rsq_f32 v82, v81
    s_nop 0
    v_mul_f32 v81, v80, v82
    v_mov_b32 v80, v82
    ds_write_b32 v70, v80
    s_add_u32 m0, s55, 79744
    s_and_b32 s6, s6, 7
    s_waitcnt lgkmcnt(5)
    v_mfma_f32_16x16x32_bf16 v[128:131], a[40:43], v[36:39], v[128:131]
    buffer_load_dwordx4 v9, s[20:23], s83 offen offset:128 lds
    v_mfma_f32_16x16x32_bf16 v[140:143], a[44:47], v[36:39], v[140:143]
    ds_write_b32 v70, v81 offset:256
    ds_read_b128 v[176:179], v69 offset:0
    ds_read_b128 v[184:187], v69 offset:256
    v_mfma_f32_16x16x32_bf16 v[152:155], v[20:23], v[36:39], v[152:155]
    ds_read_b128 v[180:183], v69 offset:16
    ds_read_b128 v[188:191], v69 offset:272
    s_waitcnt lgkmcnt(0)
    s_barrier
    ds_read_b64_tr_b16 v[24:25], v15 offset:36864
    s_add_u32 s1, s7, 896
    s_and_b32 s1, s1, 1023
    s_add_u32 s1, s1, s77
    s_add_u32 m0, s68, 32768
    s_nop 0
    buffer_load_dwordx4 v108, s[24:27], s1 offen lds
    v_mfma_f32_16x16x32_bf16 v[132:135], a[40:43], v[40:43], v[132:135]
    ds_read_b64_tr_b16 v[26:27], v15 offset:37120
    s_sub_u32 s52, s49, 1
    s_cmp_lt_u32 s52, 3
    s_cselect_b32 s54, 64, 32
    s_lshl_b32 s54, s54, 2
    v_mov_b32 v71, 1073741824
    v_cmp_gt_u32 vcc, s54, v0
    s_lshl_b32 s52, s5, 16
    s_lshl_b32 s53, s48, 7
    s_add_u32 s52, s52, s53
    s_add_u32 s52, s52, 5242880
    v_cndmask_b32 v71, v71, v126, vcc
    s_add_u32 s53, s52, 131072
    s_add_u32 s54, s52, 262144
    v_lshlrev_b32 v48, 16, v164
    v_and_b32 v49, 0xffff0000, v164
    v_mfma_f32_16x16x32_bf16 v[144:147], a[44:47], v[40:43], v[144:147]
    buffer_load_dwordx4 v109, s[24:27], s1 offen offset:1024 lds
    ds_read_b64_tr_b16 v[28:29], v16 offset:36864
    v_mfma_f32_16x16x32_bf16 v[156:159], v[20:23], v[40:43], v[156:159]
    ds_read_b64_tr_b16 v[30:31], v16 offset:37120
    v_lshlrev_b32 v50, 16, v165
    v_and_b32 v51, 0xffff0000, v165
    v_lshlrev_b32 v52, 16, v166
    v_and_b32 v53, 0xffff0000, v166
    v_lshlrev_b32 v54, 16, v167
    v_and_b32 v55, 0xffff0000, v167
    v_fma_f32 v48, v48, v176, -v184
    v_mfma_f32_16x16x32_bf16 v[136:139], a[40:43], v[44:47], v[136:139]
    ds_read_b64_tr_b16 v[32:33], v17 offset:36864
    v_fma_f32 v49, v49, v177, -v185
    v_fma_f32 v50, v50, v178, -v186
    v_fma_f32 v51, v51, v179, -v187
    v_fma_f32 v52, v52, v180, -v188
    v_fma_f32 v53, v53, v181, -v189
    v_fma_f32 v54, v54, v182, -v190
    v_fma_f32 v55, v55, v183, -v191
    v_cvt_pk_bf16_f32 v164, v48, v49
    v_mfma_f32_16x16x32_bf16 v[148:151], a[44:47], v[44:47], v[148:151]
    ds_read_b64_tr_b16 v[34:35], v17 offset:37120
    v_cvt_pk_bf16_f32 v165, v50, v51
    v_cvt_pk_bf16_f32 v166, v52, v53
    v_cvt_pk_bf16_f32 v167, v54, v55
    buffer_store_dwordx4 v[164:167], v126, s[40:43], s52 offen sc1
    v_mfma_f32_16x16x32_bf16 v[160:163], v[20:23], v[44:47], v[160:163]
    buffer_load_dwordx4 v110, s[24:27], s1 offen offset:2048 lds
    s_waitcnt lgkmcnt(4)
    v_mfma_f32_16x16x32_bf16 v[128:131], a[48:51], v[24:27], v[128:131]
    ds_read_b64_tr_b16 v[36:37], v15 offset:43008
    v_lshlrev_b32 v48, 16, v168
    v_and_b32 v49, 0xffff0000, v168
    s_mul_i32 s83, s6, 176128
    s_add_u32 m0, s55, 90112
    s_add_u32 s83, s83, s75
    v_mfma_f32_16x16x32_bf16 v[140:143], a[52:55], v[24:27], v[140:143]
    buffer_load_dwordx4 v8, s[20:23], s83 offen lds
    ds_read_b64_tr_b16 v[38:39], v15 offset:43264
    v_mfma_f32_16x16x32_bf16 v[152:155], v[20:23], v[24:27], v[152:155]
    ds_read_b64_tr_b16 v[40:41], v16 offset:43008
    v_lshlrev_b32 v50, 16, v169
    v_and_b32 v51, 0xffff0000, v169
    s_waitcnt lgkmcnt(5)
    v_mfma_f32_16x16x32_bf16 v[132:135], a[48:51], v[28:31], v[132:135]
    ds_read_b64_tr_b16 v[42:43], v16 offset:43264
    v_lshlrev_b32 v52, 16, v170
    v_and_b32 v53, 0xffff0000, v170
    v_mfma_f32_16x16x32_bf16 v[144:147], a[52:55], v[28:31], v[144:147]
    ds_read_b64_tr_b16 v[44:45], v17 offset:43008
    v_lshlrev_b32 v54, 16, v171
    v_mfma_f32_16x16x32_bf16 v[156:159], v[20:23], v[28:31], v[156:159]
    ds_read_b64_tr_b16 v[46:47], v17 offset:43264
    v_and_b32 v55, 0xffff0000, v171
    v_fma_f32 v48, v48, v176, -v184
    s_add_u32 m0, s55, 91072
    s_add_u32 s6, s6, 1
    s_waitcnt lgkmcnt(6)
    v_mfma_f32_16x16x32_bf16 v[136:139], a[48:51], v[32:35], v[136:139]
    buffer_load_dwordx4 v8, s[20:23], s83 offen offset:64 lds
    v_mfma_f32_16x16x32_bf16 v[148:151], a[52:55], v[32:35], v[148:151]
    v_fma_f32 v49, v49, v177, -v185
    v_fma_f32 v50, v50, v178, -v186
    v_fma_f32 v51, v51, v179, -v187
    v_fma_f32 v52, v52, v180, -v188
    v_mfma_f32_16x16x32_bf16 v[160:163], v[20:23], v[32:35], v[160:163]
    v_fma_f32 v53, v53, v181, -v189
    v_fma_f32 v54, v54, v182, -v190
    v_fma_f32 v55, v55, v183, -v191
    v_cvt_pk_bf16_f32 v168, v48, v49
    s_add_u32 m0, s55, 92032
    s_and_b32 s6, s6, 7
    s_waitcnt lgkmcnt(4)
    v_mfma_f32_16x16x32_bf16 v[128:131], a[56:59], v[36:39], v[128:131]
    buffer_load_dwordx4 v9, s[20:23], s83 offen offset:128 lds
    v_mfma_f32_16x16x32_bf16 v[140:143], a[60:63], v[36:39], v[140:143]
    v_cvt_pk_bf16_f32 v169, v50, v51
    v_cvt_pk_bf16_f32 v170, v52, v53
    v_cvt_pk_bf16_f32 v171, v54, v55
    v_mfma_f32_16x16x32_bf16 v[152:155], v[20:23], v[36:39], v[152:155]
    buffer_store_dwordx4 v[168:171], v126, s[40:43], s53 offen sc1
    s_waitcnt vmcnt(13)
    s_waitcnt vmcnt(11)
    s_waitcnt lgkmcnt(0)
    s_barrier
    ds_read_b64_tr_b16 v[24:25], v15 offset:0
    v_mov_b32 v4, s51
    v_mov_b32 v5, s51
    v_cmp_eq_u32 vcc, 0, v0
    v_mov_b32 v6, 1073741824
    s_lshl_b32 s78, s49, 5
    s_add_u32 s78, s78, s48
    v_cndmask_b32 v6, v6, 0, vcc
    s_lshl_b32 s78, s78, 4
    s_add_u32 s78, s78, 327680
    s_add_u32 s1, s7, 896
    s_and_b32 s1, s1, 1023
    s_add_u32 s1, s1, s77
    s_add_u32 m0, s68, 32768
    v_mfma_f32_16x16x32_bf16 v[132:135], a[56:59], v[40:43], v[132:135]
    buffer_load_dwordx4 v111, s[24:27], s1 offen offset:3072 lds
    ds_read_b64_tr_b16 v[26:27], v15 offset:256
    v_mfma_f32_16x16x32_bf16 v[144:147], a[60:63], v[40:43], v[144:147]
    ds_read_b64_tr_b16 v[28:29], v16 offset:0
    buffer_store_dwordx2 v[4:5], v6, s[40:43], s78 offen sc1
    v_lshlrev_b32 v48, 16, v172
    v_and_b32 v49, 0xffff0000, v172
    v_lshlrev_b32 v50, 16, v173
    v_and_b32 v51, 0xffff0000, v173
    v_mfma_f32_16x16x32_bf16 v[156:159], v[20:23], v[40:43], v[156:159]
    ds_read_b64_tr_b16 v[30:31], v16 offset:256
    v_lshlrev_b32 v52, 16, v174
    v_and_b32 v53, 0xffff0000, v174
    v_lshlrev_b32 v54, 16, v175
    v_and_b32 v55, 0xffff0000, v175
    v_fma_f32 v48, v48, v176, -v184
    v_fma_f32 v49, v49, v177, -v185
    v_mfma_f32_16x16x32_bf16 v[136:139], a[56:59], v[44:47], v[136:139]
    ds_read_b64_tr_b16 v[32:33], v17 offset:0
    v_fma_f32 v50, v50, v178, -v186
    v_fma_f32 v51, v51, v179, -v187
    v_fma_f32 v52, v52, v180, -v188
    v_fma_f32 v53, v53, v181, -v189
    v_fma_f32 v54, v54, v182, -v190
    v_fma_f32 v55, v55, v183, -v191
    v_cvt_pk_bf16_f32 v172, v48, v49
    v_mfma_f32_16x16x32_bf16 v[148:151], a[60:63], v[44:47], v[148:151]
    ds_read_b64_tr_b16 v[34:35], v17 offset:256
    v_cvt_pk_bf16_f32 v173, v50, v51
    v_cvt_pk_bf16_f32 v174, v52, v53
    v_cvt_pk_bf16_f32 v175, v54, v55
    buffer_store_dwordx4 v[172:175], v71, s[40:43], s54 offen sc1
    s_add_u32 m0, s68, 36864
    v_mfma_f32_16x16x32_bf16 v[160:163], v[20:23], v[44:47], v[160:163]
    buffer_load_dwordx4 v112, s[24:27], s1 offen lds
    s_waitcnt lgkmcnt(4)
    v_mfma_f32_16x16x32_bf16 v[128:131], a[64:67], v[24:27], v[128:131]
    ds_read_b64_tr_b16 v[36:37], v15 offset:6144
    s_mul_i32 s83, s6, 176128
    s_add_u32 m0, s55, 102400
    s_add_u32 s83, s83, s75
    v_mfma_f32_16x16x32_bf16 v[140:143], a[68:71], v[24:27], v[140:143]
    buffer_load_dwordx4 v8, s[20:23], s83 offen lds
    ds_read_b64_tr_b16 v[38:39], v15 offset:6400
    v_mfma_f32_16x16x32_bf16 v[152:155], v[20:23], v[24:27], v[152:155]
    ds_read_b64_tr_b16 v[40:41], v16 offset:6144
    s_waitcnt lgkmcnt(5)
    v_mfma_f32_16x16x32_bf16 v[132:135], a[64:67], v[28:31], v[132:135]
    ds_read_b64_tr_b16 v[42:43], v16 offset:6400
    v_mfma_f32_16x16x32_bf16 v[144:147], a[68:71], v[28:31], v[144:147]
    ds_read_b64_tr_b16 v[44:45], v17 offset:6144
    v_mfma_f32_16x16x32_bf16 v[156:159], v[20:23], v[28:31], v[156:159]
    ds_read_b64_tr_b16 v[46:47], v17 offset:6400
    s_add_u32 m0, s55, 103360
    s_add_u32 s6, s6, 1
    s_waitcnt lgkmcnt(6)
    v_mfma_f32_16x16x32_bf16 v[136:139], a[64:67], v[32:35], v[136:139]
    buffer_load_dwordx4 v8, s[20:23], s83 offen offset:64 lds
    v_mfma_f32_16x16x32_bf16 v[148:151], a[68:71], v[32:35], v[148:151]
    ds_read_b128 a[192:195], v11 offset:0
    v_mfma_f32_16x16x32_bf16 v[160:163], v[20:23], v[32:35], v[160:163]
    ds_read_b128 a[196:199], v11 offset:4096
    s_add_u32 m0, s55, 104320
    s_and_b32 s6, s6, 7
    s_waitcnt lgkmcnt(6)
    v_mfma_f32_16x16x32_bf16 v[128:131], a[72:75], v[36:39], v[128:131]
    buffer_load_dwordx4 v9, s[20:23], s83 offen offset:128 lds
    v_mfma_f32_16x16x32_bf16 v[140:143], a[76:79], v[36:39], v[140:143]
    ds_read_b128 a[200:203], v12 offset:0
    v_mfma_f32_16x16x32_bf16 v[152:155], v[20:23], v[36:39], v[152:155]
    ds_read_b128 a[204:207], v12 offset:4096
    ds_read_b128 a[208:211], v13 offset:0
    ds_read_b128 a[212:215], v13 offset:4096
    ds_read_b128 a[216:219], v14 offset:0
    ds_read_b128 a[220:223], v14 offset:4096
    s_waitcnt vmcnt(15)
    s_waitcnt lgkmcnt(0)
    s_barrier
    ds_read_b64_tr_b16 v[24:25], v15 offset:12288
    s_add_u32 s1, s7, 896
    s_and_b32 s1, s1, 1023
    s_add_u32 s1, s1, s77
    s_add_u32 m0, s68, 36864
    s_nop 0
    buffer_load_dwordx4 v113, s[24:27], s1 offen offset:1024 lds
    v_mfma_f32_16x16x32_bf16 v[132:135], a[72:75], v[40:43], v[132:135]
    ds_read_b64_tr_b16 v[26:27], v15 offset:12544
    v_mfma_f32_16x16x32_bf16 v[144:147], a[76:79], v[40:43], v[144:147]
    buffer_load_dwordx4 v114, s[24:27], s1 offen offset:2048 lds
    ds_read_b64_tr_b16 v[28:29], v16 offset:12288
    v_mfma_f32_16x16x32_bf16 v[156:159], v[20:23], v[40:43], v[156:159]
    ds_read_b64_tr_b16 v[30:31], v16 offset:12544
    v_mfma_f32_16x16x32_bf16 v[136:139], a[72:75], v[44:47], v[136:139]
    ds_read_b64_tr_b16 v[32:33], v17 offset:12288
    v_mfma_f32_16x16x32_bf16 v[148:151], a[76:79], v[44:47], v[148:151]
    ds_read_b64_tr_b16 v[34:35], v17 offset:12544
    v_mfma_f32_16x16x32_bf16 v[160:163], v[20:23], v[44:47], v[160:163]
    buffer_load_dwordx4 v115, s[24:27], s1 offen offset:3072 lds
    s_waitcnt lgkmcnt(4)
    v_mfma_f32_16x16x32_bf16 v[128:131], a[80:83], v[24:27], v[128:131]
    ds_read_b64_tr_b16 v[36:37], v15 offset:18432
    s_add_u32 s1, s7, 0
    s_and_b32 s1, s1, 1023
    s_add_u32 s1, s1, s77
    s_add_u32 m0, s68, 0
    v_mfma_f32_16x16x32_bf16 v[140:143], a[84:87], v[24:27], v[140:143]
    buffer_load_dwordx4 v108, s[24:27], s1 offen lds
    ds_read_b64_tr_b16 v[38:39], v15 offset:18688
    v_mfma_f32_16x16x32_bf16 v[152:155], v[20:23], v[24:27], v[152:155]
    ds_read_b64_tr_b16 v[40:41], v16 offset:18432
    s_waitcnt lgkmcnt(5)
    v_mfma_f32_16x16x32_bf16 v[132:135], a[80:83], v[28:31], v[132:135]
    ds_read_b64_tr_b16 v[42:43], v16 offset:18688
    v_mfma_f32_16x16x32_bf16 v[144:147], a[84:87], v[28:31], v[144:147]
    buffer_load_dwordx4 v109, s[24:27], s1 offen offset:1024 lds
    ds_read_b64_tr_b16 v[44:45], v17 offset:18432
    v_mfma_f32_16x16x32_bf16 v[156:159], v[20:23], v[28:31], v[156:159]
    ds_read_b64_tr_b16 v[46:47], v17 offset:18688
    s_waitcnt lgkmcnt(6)
    v_mfma_f32_16x16x32_bf16 v[136:139], a[80:83], v[32:35], v[136:139]
    v_mfma_f32_16x16x32_bf16 v[148:151], a[84:87], v[32:35], v[148:151]
    buffer_load_dwordx4 v110, s[24:27], s1 offen offset:2048 lds
    v_mfma_f32_16x16x32_bf16 v[160:163], v[20:23], v[32:35], v[160:163]
    s_waitcnt lgkmcnt(4)
    v_mfma_f32_16x16x32_bf16 v[128:131], a[88:91], v[36:39], v[128:131]
    v_mfma_f32_16x16x32_bf16 v[140:143], a[92:95], v[36:39], v[140:143]
    buffer_load_dwordx4 v111, s[24:27], s1 offen offset:3072 lds
    v_mfma_f32_16x16x32_bf16 v[152:155], v[20:23], v[36:39], v[152:155]
    s_waitcnt vmcnt(15)
    s_waitcnt vmcnt(11)
    s_waitcnt lgkmcnt(0)
    s_barrier
    ds_read_b64_tr_b16 v[24:25], v15 offset:24576
    s_add_u32 s1, s7, 0
    s_and_b32 s1, s1, 1023
    s_add_u32 s1, s1, s77
    s_add_u32 m0, s68, 4096
    s_nop 0
    buffer_load_dwordx4 v112, s[24:27], s1 offen lds
    v_mfma_f32_16x16x32_bf16 v[132:135], a[88:91], v[40:43], v[132:135]
    buffer_load_dwordx4 v113, s[24:27], s1 offen offset:1024 lds
    ds_read_b64_tr_b16 v[26:27], v15 offset:24832
    v_mfma_f32_16x16x32_bf16 v[144:147], a[92:95], v[40:43], v[144:147]
    ds_read_b64_tr_b16 v[28:29], v16 offset:24576
    v_mov_b32 v4, s51
    v_mov_b32 v5, s51
    v_cmp_eq_u32 vcc, 0, v0
    v_mfma_f32_16x16x32_bf16 v[156:159], v[20:23], v[40:43], v[156:159]
    buffer_load_dwordx4 v114, s[24:27], s1 offen offset:2048 lds
    ds_read_b64_tr_b16 v[30:31], v16 offset:24832
    v_mfma_f32_16x16x32_bf16 v[136:139], a[88:91], v[44:47], v[136:139]
    ds_read_b64_tr_b16 v[32:33], v17 offset:24576
    v_mov_b32 v6, 1073741824
    s_lshl_b32 s52, s49, 5
    s_add_u32 s52, s52, s48
    v_cndmask_b32 v6, v6, 0, vcc
    s_lshl_b32 s52, s52, 4
    s_add_u32 s52, s52, 393216
    v_mfma_f32_16x16x32_bf16 v[148:151], a[92:95], v[44:47], v[148:151]
    ds_read_b64_tr_b16 v[34:35], v17 offset:24832
    buffer_store_dwordx2 v[4:5], v6, s[40:43], s52 offen sc1
    v_mfma_f32_16x16x32_bf16 v[160:163], v[20:23], v[44:47], v[160:163]
    buffer_load_dwordx4 v115, s[24:27], s1 offen offset:3072 lds
    s_waitcnt lgkmcnt(4)
    v_mfma_f32_16x16x32_bf16 v[128:131], a[96:99], v[24:27], v[128:131]
    ds_read_b64_tr_b16 v[36:37], v15 offset:30720
    s_waitcnt vmcnt(9)
    v_mfma_f32_16x16x32_bf16 v[140:143], a[100:103], v[24:27], v[140:143]
    ds_read_b64_tr_b16 v[38:39], v15 offset:30976
    v_mfma_f32_16x16x32_bf16 v[152:155], v[20:23], v[24:27], v[152:155]
    ds_read_b64_tr_b16 v[40:41], v16 offset:30720
    s_waitcnt lgkmcnt(5)
    v_mfma_f32_16x16x32_bf16 v[132:135], a[96:99], v[28:31], v[132:135]
    ds_read_b64_tr_b16 v[42:43], v16 offset:30976
    v_mfma_f32_16x16x32_bf16 v[144:147], a[100:103], v[28:31], v[144:147]
    ds_read_b64_tr_b16 v[44:45], v17 offset:30720
    v_mfma_f32_16x16x32_bf16 v[156:159], v[20:23], v[28:31], v[156:159]
    ds_read_b64_tr_b16 v[46:47], v17 offset:30976
    s_waitcnt lgkmcnt(6)
    v_mfma_f32_16x16x32_bf16 v[136:139], a[96:99], v[32:35], v[136:139]
    ds_read_b128 a[224:227], v11 offset:32768
    v_mfma_f32_16x16x32_bf16 v[148:151], a[100:103], v[32:35], v[148:151]
    ds_read_b128 a[228:231], v11 offset:36864
    v_mfma_f32_16x16x32_bf16 v[160:163], v[20:23], v[32:35], v[160:163]
    ds_read_b128 a[232:235], v12 offset:32768
    s_waitcnt lgkmcnt(7)
    v_mfma_f32_16x16x32_bf16 v[128:131], a[104:107], v[36:39], v[128:131]
    ds_read_b128 a[236:239], v12 offset:36864
    v_mfma_f32_16x16x32_bf16 v[140:143], a[108:111], v[36:39], v[140:143]
    ds_read_b128 a[240:243], v13 offset:32768
    v_mfma_f32_16x16x32_bf16 v[152:155], v[20:23], v[36:39], v[152:155]
    ds_read_b128 a[244:247], v13 offset:36864
    ds_read_b128 a[248:251], v14 offset:32768
    ds_read_b128 a[252:255], v14 offset:36864
    s_waitcnt lgkmcnt(0)
    s_barrier
    ds_read_b64_tr_b16 v[24:25], v15 offset:36864
    s_add_u32 s1, s7, 128
    s_and_b32 s1, s1, 1023
    s_add_u32 s1, s1, s77
    s_add_u32 m0, s68, 32768
    v_mfma_f32_16x16x32_bf16 v[132:135], a[104:107], v[40:43], v[132:135]
    buffer_load_dwordx4 v108, s[24:27], s1 offen lds
    ds_read_b64_tr_b16 v[26:27], v15 offset:37120
    v_mfma_f32_16x16x32_bf16 v[144:147], a[108:111], v[40:43], v[144:147]
    ds_read_b64_tr_b16 v[28:29], v16 offset:36864
    v_mfma_f32_16x16x32_bf16 v[156:159], v[20:23], v[40:43], v[156:159]
    ds_read_b64_tr_b16 v[30:31], v16 offset:37120
    v_mfma_f32_16x16x32_bf16 v[136:139], a[104:107], v[44:47], v[136:139]
    ds_read_b64_tr_b16 v[32:33], v17 offset:36864
    v_mfma_f32_16x16x32_bf16 v[148:151], a[108:111], v[44:47], v[148:151]
    ds_read_b64_tr_b16 v[34:35], v17 offset:37120
    v_mfma_f32_16x16x32_bf16 v[160:163], v[20:23], v[44:47], v[160:163]
    buffer_load_dwordx4 v109, s[24:27], s1 offen offset:1024 lds
    s_waitcnt lgkmcnt(4)
    v_mfma_f32_16x16x32_bf16 v[128:131], a[112:115], v[24:27], v[128:131]
    ds_read_b64_tr_b16 v[36:37], v15 offset:43008
    v_and_b32 v1, 31, v0
    s_add_u32 s1, s7, 128
    s_and_b32 s1, s1, 1023
    s_add_u32 s1, s1, s77
    s_add_u32 m0, s68, 32768
    v_mfma_f32_16x16x32_bf16 v[140:143], a[116:119], v[24:27], v[140:143]
    buffer_load_dwordx4 v110, s[24:27], s1 offen offset:2048 lds
    ds_read_b64_tr_b16 v[38:39], v15 offset:43264
    v_mfma_f32_16x16x32_bf16 v[152:155], v[20:23], v[24:27], v[152:155]
    ds_read_b64_tr_b16 v[40:41], v16 offset:43008
    v_lshlrev_b32 v1, 4, v1
    s_waitcnt lgkmcnt(5)
    v_mfma_f32_16x16x32_bf16 v[132:135], a[112:115], v[28:31], v[132:135]
    ds_read_b64_tr_b16 v[42:43], v16 offset:43264
    s_lshl_b32 s80, s49, 9
    s_add_u32 s80, s80, 327680
    v_mfma_f32_16x16x32_bf16 v[144:147], a[116:119], v[28:31], v[144:147]
    buffer_load_dwordx4 v111, s[24:27], s1 offen offset:3072 lds
    ds_read_b64_tr_b16 v[44:45], v17 offset:43008
    v_mfma_f32_16x16x32_bf16 v[156:159], v[20:23], v[28:31], v[156:159]
    ds_read_b64_tr_b16 v[46:47], v17 offset:43264
    s_waitcnt lgkmcnt(6)
    v_mfma_f32_16x16x32_bf16 v[136:139], a[112:115], v[32:35], v[136:139]
    s_add_u32 m0, s68, 36864
    v_mfma_f32_16x16x32_bf16 v[148:151], a[116:119], v[32:35], v[148:151]
    buffer_load_dwordx4 v112, s[24:27], s1 offen lds
    v_mfma_f32_16x16x32_bf16 v[160:163], v[20:23], v[32:35], v[160:163]
    s_waitcnt lgkmcnt(4)
    v_mfma_f32_16x16x32_bf16 v[128:131], a[120:123], v[36:39], v[128:131]
    s_add_u32 s1, s7, 128
    s_and_b32 s1, s1, 1023
    s_add_u32 s1, s1, s77
    s_add_u32 m0, s68, 36864
    v_mfma_f32_16x16x32_bf16 v[140:143], a[124:127], v[36:39], v[140:143]
    buffer_load_dwordx4 v113, s[24:27], s1 offen offset:1024 lds
    v_mfma_f32_16x16x32_bf16 v[152:155], v[20:23], v[36:39], v[152:155]
    s_waitcnt lgkmcnt(2)
    v_mfma_f32_16x16x32_bf16 v[132:135], a[120:123], v[40:43], v[132:135]
    v_mfma_f32_16x16x32_bf16 v[144:147], a[124:127], v[40:43], v[144:147]
    buffer_load_dwordx4 v114, s[24:27], s1 offen offset:2048 lds
    v_mfma_f32_16x16x32_bf16 v[156:159], v[20:23], v[40:43], v[156:159]
    s_waitcnt lgkmcnt(0)
    v_mfma_f32_16x16x32_bf16 v[136:139], a[120:123], v[44:47], v[136:139]
    v_mfma_f32_16x16x32_bf16 v[148:151], a[124:127], v[44:47], v[148:151]
    buffer_load_dwordx4 v115, s[24:27], s1 offen offset:3072 lds
    v_mfma_f32_16x16x32_bf16 v[160:163], v[20:23], v[44:47], v[160:163]
    buffer_load_dwordx2 v[18:19], v1, s[40:43], s80 offen sc1
    s_lshl_b32 s81, s49, 5
    s_add_u32 s81, s81, s48
    s_lshl_b32 s52, s81, 13
    s_lshl_b32 s53, s50, 11
    s_add_u32 s52, s52, s53
    s_add_u32 s54, s52, 3145728
    s_add_u32 s52, s52, 1048576
    v_and_b32 v4, 63, v0
    v_lshlrev_b32 v4, 4, v4
    s_waitcnt vmcnt(9)
    ds_read_b128 a[0:3], v11 offset:0
    ds_read_b128 a[4:7], v11 offset:4096
    ds_read_b128 a[8:11], v12 offset:0
    ds_read_b128 a[12:15], v12 offset:4096
    ds_read_b128 a[16:19], v13 offset:0
    ds_read_b128 a[20:23], v13 offset:4096
    ds_read_b128 a[24:27], v14 offset:0
    ds_read_b128 a[28:31], v14 offset:4096
    v_mov_b32 v2, 0xc0135761
    v_mov_b32 v3, v2
    v_add_u32 v124, 35328, v124
    v_add_u32 v125, 35328, v125
    v_pk_mul_f32 v[24:25], v[100:101], v[152:153]
    v_pk_mul_f32 v[26:27], v[102:103], v[152:153]
    v_pk_mul_f32 v[36:37], v[104:105], v[152:153]
    v_pk_mul_f32 v[38:39], v[106:107], v[152:153]
    v_pk_fma_f32 v[24:25], v[128:129], v[92:93], v[24:25] neg_lo:[0,0,1] neg_hi:[0,0,1]
    v_pk_fma_f32 v[26:27], v[130:131], v[94:95], v[26:27] neg_lo:[0,0,1] neg_hi:[0,0,1]
    v_pk_fma_f32 v[36:37], v[140:141], v[96:97], v[36:37] neg_lo:[0,0,1] neg_hi:[0,0,1]
    v_pk_fma_f32 v[38:39], v[142:143], v[98:99], v[38:39] neg_lo:[0,0,1] neg_hi:[0,0,1]
    s_waitcnt lgkmcnt(0)
    s_add_u32 s1, s7, 256
    s_and_b32 s1, s1, 1023
    s_add_u32 s1, s1, s77
    s_add_u32 m0, s68, 0
    s_nop 0
    buffer_load_dwordx4 v108, s[24:27], s1 offen lds
    v_pk_mul_f32 v[28:29], v[24:25], v[24:25]
    v_pk_mul_f32 v[30:31], v[26:27], v[26:27]
    v_pk_mul_f32 v[40:41], v[36:37], v[36:37]
    v_pk_mul_f32 v[42:43], v[38:39], v[38:39]
    v_pk_fma_f32 v[28:29], v[28:29], s[64:65], v[2:3]
    v_pk_fma_f32 v[30:31], v[30:31], s[64:65], v[2:3]
    v_pk_fma_f32 v[40:41], v[40:41], s[64:65], v[2:3]
    v_pk_fma_f32 v[42:43], v[42:43], s[64:65], v[2:3]
    v_pk_mul_f32 v[28:29], v[28:29], v[24:25]
    v_pk_mul_f32 v[30:31], v[30:31], v[26:27]
    v_pk_mul_f32 v[40:41], v[40:41], v[36:37]
    v_pk_mul_f32 v[42:43], v[42:43], v[38:39]
    v_exp_f32 v32, v28
    buffer_load_dwordx4 v109, s[24:27], s1 offen offset:1024 lds
    v_exp_f32 v33, v29
    v_exp_f32 v34, v30
    v_exp_f32 v35, v31
    v_exp_f32 v44, v40
    v_exp_f32 v45, v41
    v_exp_f32 v46, v42
    buffer_load_dwordx4 v110, s[24:27], s1 offen offset:2048 lds
    v_exp_f32 v47, v43
    v_pk_add_f32 v[32:33], v[32:33], s[66:67]
    v_pk_add_f32 v[34:35], v[34:35], s[66:67]
    v_pk_add_f32 v[44:45], v[44:45], s[66:67]
    v_pk_add_f32 v[46:47], v[46:47], s[66:67]
    v_rcp_f32 v32, v32
    v_rcp_f32 v33, v33
    v_rcp_f32 v34, v34
    buffer_load_dwordx4 v111, s[24:27], s1 offen offset:3072 lds
    v_rcp_f32 v35, v35
    v_rcp_f32 v44, v44
    v_rcp_f32 v45, v45
    v_rcp_f32 v46, v46
    v_rcp_f32 v47, v47
    v_pk_mul_f32 v[24:25], v[24:25], v[32:33]
    s_add_u32 m0, s68, 4096
    s_nop 0
    buffer_load_dwordx4 v112, s[24:27], s1 offen lds
    v_pk_mul_f32 v[26:27], v[26:27], v[34:35]
    v_pk_mul_f32 v[36:37], v[36:37], v[44:45]
    v_pk_mul_f32 v[38:39], v[38:39], v[46:47]
    v_cvt_pk_bf16_f32 v128, v24, v25
    v_cvt_pk_bf16_f32 v129, v26, v27
    v_cvt_pk_bf16_f32 v140, v36, v37
    v_cvt_pk_bf16_f32 v141, v38, v39
    ds_write_b64 v124, v[128:129] offset:0
    v_pk_mul_f32 v[24:25], v[100:101], v[156:157]
    v_pk_mul_f32 v[26:27], v[102:103], v[156:157]
    v_pk_mul_f32 v[36:37], v[104:105], v[156:157]
    v_pk_mul_f32 v[38:39], v[106:107], v[156:157]
    buffer_load_dwordx4 v113, s[24:27], s1 offen offset:1024 lds
    v_pk_fma_f32 v[24:25], v[132:133], v[92:93], v[24:25] neg_lo:[0,0,1] neg_hi:[0,0,1]
    v_pk_fma_f32 v[26:27], v[134:135], v[94:95], v[26:27] neg_lo:[0,0,1] neg_hi:[0,0,1]
    v_pk_fma_f32 v[36:37], v[144:145], v[96:97], v[36:37] neg_lo:[0,0,1] neg_hi:[0,0,1]
    v_pk_fma_f32 v[38:39], v[146:147], v[98:99], v[38:39] neg_lo:[0,0,1] neg_hi:[0,0,1]
    ds_write_b64 v125, v[140:141] offset:0
    v_pk_mul_f32 v[28:29], v[24:25], v[24:25]
    v_pk_mul_f32 v[30:31], v[26:27], v[26:27]
    v_pk_mul_f32 v[40:41], v[36:37], v[36:37]
    v_pk_mul_f32 v[42:43], v[38:39], v[38:39]
    v_pk_fma_f32 v[28:29], v[28:29], s[64:65], v[2:3]
    v_pk_fma_f32 v[30:31], v[30:31], s[64:65], v[2:3]
    v_pk_fma_f32 v[40:41], v[40:41], s[64:65], v[2:3]
    s_waitcnt vmcnt(6)
    v_cmp_ne_u32 vcc, s51, v18
    v_cmp_ne_u32 s[100:101], s51, v19
    s_nop 0
    s_or_b64 vcc, vcc, s[100:101]
    s_cbranch_scc0 L_ok1
    s_mov_b32 s78, 0x200000
L_poll1:
    s_sleep 1
    buffer_load_dwordx2 v[18:19], v1, s[40:43], s80 offen sc1
    s_sub_u32 s78, s78, 1
    s_cbranch_scc1 L_end
    s_waitcnt vmcnt(0)
    v_cmp_ne_u32 vcc, s51, v18
    v_cmp_ne_u32 s[100:101], s51, v19
    s_nop 0
    s_or_b64 vcc, vcc, s[100:101]
    s_cbranch_scc1 L_poll1
L_ok1:
    s_add_u32 m0, s53, 136704
    buffer_load_dwordx4 v[184:187], v4, s[40:43], s54 offen offset:0
    buffer_load_dwordx4 v[188:191], v4, s[40:43], s54 offen offset:1024
    buffer_load_dwordx4 v4, s[40:43], s52 offen lds
    buffer_load_dwordx4 v4, s[40:43], s52 offen offset:1024 lds
    v_and_b32 v15, 7, v0
    v_lshlrev_b32 v15, 4, v15
    v_bfe_u32 v5, v0, 3, 1
    v_lshl_add_u32 v15, v5, 9, v15
    s_max_u32 s80, s49, 1
    s_sub_u32 s80, s80, 1
    s_lshl_b32 s80, s80, 9
    s_lshl_b32 s53, s50, 7
    s_add_u32 s80, s80, s53
    s_add_u32 s80, s80, 393216
    s_mul_i32 s82, s50, 11264
    s_mul_i32 s79, s49, 352256
    s_lshl_b32 s53, s50, 10
    s_add_u32 s79, s79, s53
    s_add_u32 s79, s79, 5242880
    s_add_u32 s1, s7, 256
    s_and_b32 s1, s1, 1023
    s_add_u32 s1, s1, s77
    s_add_u32 m0, s68, 4096
    s_nop 0
    buffer_load_dwordx4 v114, s[24:27], s1 offen offset:2048 lds
    v_pk_fma_f32 v[42:43], v[42:43], s[64:65], v[2:3]
    v_pk_mul_f32 v[28:29], v[28:29], v[24:25]
    v_pk_mul_f32 v[30:31], v[30:31], v[26:27]
    v_pk_mul_f32 v[40:41], v[40:41], v[36:37]
    v_pk_mul_f32 v[42:43], v[42:43], v[38:39]
    v_exp_f32 v32, v28
    buffer_load_dwordx4 v115, s[24:27], s1 offen offset:3072 lds
    v_exp_f32 v33, v29
    v_exp_f32 v34, v30
    ds_read_b128 a[32:35], v11 offset:32768
    ds_read_b128 a[36:39], v11 offset:36864
    ds_read_b128 a[40:43], v12 offset:32768
    ds_read_b128 a[44:47], v12 offset:36864
    ds_read_b128 a[48:51], v13 offset:32768
    ds_read_b128 a[52:55], v13 offset:36864
    ds_read_b128 a[56:59], v14 offset:32768
    ds_read_b128 a[60:63], v14 offset:36864
    v_exp_f32 v35, v31
    v_exp_f32 v44, v40
    v_exp_f32 v45, v41
    v_exp_f32 v46, v42
    v_exp_f32 v47, v43
    v_pk_add_f32 v[32:33], v[32:33], s[66:67]
    v_pk_add_f32 v[34:35], v[34:35], s[66:67]
    v_pk_add_f32 v[44:45], v[44:45], s[66:67]
    v_pk_add_f32 v[46:47], v[46:47], s[66:67]
    v_rcp_f32 v32, v32
    v_rcp_f32 v33, v33
    v_rcp_f32 v34, v34
    s_waitcnt lgkmcnt(0)
    s_add_u32 s1, s7, 384
    s_and_b32 s1, s1, 1023
    s_add_u32 s1, s1, s77
    s_add_u32 m0, s68, 32768
    s_nop 0
    buffer_load_dwordx4 v108, s[24:27], s1 offen lds
    v_rcp_f32 v35, v35
    v_rcp_f32 v44, v44
    v_rcp_f32 v45, v45
    v_rcp_f32 v46, v46
    v_rcp_f32 v47, v47
    v_pk_mul_f32 v[24:25], v[24:25], v[32:33]
    buffer_load_dwordx4 v109, s[24:27], s1 offen offset:1024 lds
    v_pk_mul_f32 v[26:27], v[26:27], v[34:35]
    v_pk_mul_f32 v[36:37], v[36:37], v[44:45]
    v_pk_mul_f32 v[38:39], v[38:39], v[46:47]
    v_cvt_pk_bf16_f32 v132, v24, v25
    v_cvt_pk_bf16_f32 v133, v26, v27
    v_cvt_pk_bf16_f32 v144, v36, v37
    v_cvt_pk_bf16_f32 v145, v38, v39
    ds_write_b64 v124, v[132:133] offset:2304
    v_pk_mul_f32 v[24:25], v[100:101], v[160:161]
    v_pk_mul_f32 v[26:27], v[102:103], v[160:161]
    v_pk_mul_f32 v[36:37], v[104:105], v[160:161]
    buffer_load_dwordx4 v110, s[24:27], s1 offen offset:2048 lds
    v_pk_mul_f32 v[38:39], v[106:107], v[160:161]
    v_pk_fma_f32 v[24:25], v[136:137], v[92:93], v[24:25] neg_lo:[0,0,1] neg_hi:[0,0,1]
    v_pk_fma_f32 v[26:27], v[138:139], v[94:95], v[26:27] neg_lo:[0,0,1] neg_hi:[0,0,1]
    v_pk_fma_f32 v[36:37], v[148:149], v[96:97], v[36:37] neg_lo:[0,0,1] neg_hi:[0,0,1]
    v_pk_fma_f32 v[38:39], v[150:151], v[98:99], v[38:39] neg_lo:[0,0,1] neg_hi:[0,0,1]
    ds_write_b64 v125, v[144:145] offset:2304
    v_pk_mul_f32 v[28:29], v[24:25], v[24:25]
    v_pk_mul_f32 v[30:31], v[26:27], v[26:27]
    v_pk_mul_f32 v[40:41], v[36:37], v[36:37]
    v_pk_mul_f32 v[42:43], v[38:39], v[38:39]
    v_pk_fma_f32 v[28:29], v[28:29], s[64:65], v[2:3]
    buffer_load_dwordx4 v111, s[24:27], s1 offen offset:3072 lds
    v_pk_fma_f32 v[30:31], v[30:31], s[64:65], v[2:3]
    v_pk_fma_f32 v[40:41], v[40:41], s[64:65], v[2:3]
    v_pk_fma_f32 v[42:43], v[42:43], s[64:65], v[2:3]
    v_pk_mul_f32 v[28:29], v[28:29], v[24:25]
    v_pk_mul_f32 v[30:31], v[30:31], v[26:27]
    v_pk_mul_f32 v[40:41], v[40:41], v[36:37]
    v_pk_mul_f32 v[42:43], v[42:43], v[38:39]
    v_exp_f32 v32, v28
    v_exp_f32 v33, v29
    s_add_u32 m0, s68, 36864
    s_nop 0
    buffer_load_dwordx4 v112, s[24:27], s1 offen lds
    v_exp_f32 v34, v30
    v_exp_f32 v35, v31
    v_exp_f32 v44, v40
    v_exp_f32 v45, v41
    v_exp_f32 v46, v42
    buffer_load_dwordx4 v113, s[24:27], s1 offen offset:1024 lds
    v_exp_f32 v47, v43
    v_pk_add_f32 v[32:33], v[32:33], s[66:67]
    v_pk_add_f32 v[34:35], v[34:35], s[66:67]
    v_pk_add_f32 v[44:45], v[44:45], s[66:67]
    v_pk_add_f32 v[46:47], v[46:47], s[66:67]
    v_rcp_f32 v32, v32
    v_rcp_f32 v33, v33
    v_rcp_f32 v34, v34
    buffer_load_dwordx4 v114, s[24:27], s1 offen offset:2048 lds
    v_rcp_f32 v35, v35
    v_rcp_f32 v44, v44
    v_rcp_f32 v45, v45
    v_rcp_f32 v46, v46
    v_rcp_f32 v47, v47
    buffer_load_dwordx4 v115, s[24:27], s1 offen offset:3072 lds
    v_pk_mul_f32 v[24:25], v[24:25], v[32:33]
    v_pk_mul_f32 v[26:27], v[26:27], v[34:35]
    v_pk_mul_f32 v[36:37], v[36:37], v[44:45]
    v_pk_mul_f32 v[38:39], v[38:39], v[46:47]
    v_cvt_pk_bf16_f32 v136, v24, v25
    v_cvt_pk_bf16_f32 v137, v26, v27
    v_cvt_pk_bf16_f32 v148, v36, v37
    v_cvt_pk_bf16_f32 v149, v38, v39
    ds_write_b64 v124, v[136:137] offset:4608
    ds_write_b64 v125, v[148:149] offset:4608
    buffer_load_dwordx2 v[18:19], v15, s[40:43], s80 offen sc1
    v_bfe_u32 v2, v0, 4, 2
    v_bfe_u32 v3, v0, 2, 2
    v_lshl_add_u32 v3, v2, 3, v3
    v_and_b32 v4, 3, v0
    v_lshlrev_b32 v4, 4, v4
    v_lshl_add_u32 v16, v3, 6, v4
    v_add_u32 v16, 136704, v16
    s_waitcnt vmcnt(9)
    ds_read_b128 a[64:67], v11 offset:0
    ds_read_b128 a[68:71], v11 offset:4096
    ds_read_b128 a[72:75], v12 offset:0
    ds_read_b128 a[76:79], v12 offset:4096
    ds_read_b128 a[80:83], v13 offset:0
    ds_read_b128 a[84:87], v13 offset:4096
    ds_read_b128 a[88:91], v14 offset:0
    ds_read_b128 a[92:95], v14 offset:4096
    s_waitcnt vmcnt(0)
    v_cmp_ne_u32 vcc, s51, v18
    v_cmp_ne_u32 s[100:101], s51, v19
    s_nop 0
    s_or_b64 vcc, vcc, s[100:101]
    s_cbranch_scc0 L_ok2
    s_mov_b32 s78, 0x200000
L_poll2:
    s_sleep 1
    buffer_load_dwordx2 v[18:19], v15, s[40:43], s80 offen sc1
    s_sub_u32 s78, s78, 1
    s_cbranch_scc1 L_end
    s_waitcnt vmcnt(0)
    v_cmp_ne_u32 vcc, s51, v18
    v_cmp_ne_u32 s[100:101], s51, v19
    s_nop 0
    s_or_b64 vcc, vcc, s[100:101]
    s_cbranch_scc1 L_poll2
L_ok2:
    s_waitcnt lgkmcnt(0)
    s_barrier
    ds_read_b64_tr_b16 v[128:129], v16 offset:0
    ds_read_b64_tr_b16 v[130:131], v16 offset:256
    ds_read_b64_tr_b16 v[136:137], v16 offset:8
    ds_read_b64_tr_b16 v[138:139], v16 offset:264
    ds_read_b64_tr_b16 v[144:145], v16 offset:4096
    ds_read_b64_tr_b16 v[146:147], v16 offset:4352
    ds_read_b64_tr_b16 v[152:153], v16 offset:4104
    ds_read_b64_tr_b16 v[154:155], v16 offset:4360
    ds_read_b64_tr_b16 v[132:133], v16 offset:2048
    ds_read_b64_tr_b16 v[134:135], v16 offset:2304
    ds_read_b64_tr_b16 v[140:141], v16 offset:2056
    ds_read_b64_tr_b16 v[142:143], v16 offset:2312
    ds_read_b64_tr_b16 v[148:149], v16 offset:6144
    ds_read_b64_tr_b16 v[150:151], v16 offset:6400
    ds_read_b64_tr_b16 v[156:157], v16 offset:6152
    ds_read_b64_tr_b16 v[158:159], v16 offset:6408
    s_add_u32 s1, s7, 0
    s_and_b32 s1, s1, 1023
    s_add_u32 s1, s1, s79
    s_add_u32 m0, s82, 90112
    s_nop 0
    buffer_load_dwordx4 v108, s[40:43], s1 offen lds
    buffer_load_dwordx4 v109, s[40:43], s1 offen offset:1024 lds
    buffer_load_dwordx4 v110, s[40:43], s1 offen offset:2048 lds
    buffer_load_dwordx4 v111, s[40:43], s1 offen offset:3072 lds
    s_add_u32 m0, s82, 94208
    s_nop 0
    buffer_load_dwordx4 v112, s[40:43], s1 offen lds
    s_waitcnt lgkmcnt(14)
    v_mfma_f32_16x16x32_bf16 v[160:163], v[128:131], v[192:195], 0
    v_and_b32 v3, 15, v0
    v_lshlrev_b32 v3, 6, v3
    s_waitcnt lgkmcnt(10)
    v_mfma_f32_16x16x32_bf16 v[168:171], v[144:147], v[192:195], 0
    v_lshl_add_u32 v3, v2, 4, v3
    s_lshl_b32 s53, s50, 10
    s_add_u32 s53, s53, 136704
    v_mfma_f32_16x16x32_bf16 v[164:167], v[136:139], v[192:195], 0
    v_add_u32 v17, s53, v3
    s_waitcnt lgkmcnt(8)
    v_mfma_f32_16x16x32_bf16 v[172:175], v[152:155], v[192:195], 0
    ds_read_b128 a[96:99], v11 offset:32768
    v_mfma_f32_16x16x32_bf16 v[160:163], v[144:147], v[200:203], v[160:163]
    ds_read_b128 a[100:103], v11 offset:36864
    v_mfma_f32_16x16x32_bf16 v[168:171], v[128:131], v[208:211], v[168:171]
    ds_read_b128 a[104:107], v12 offset:32768
    v_mfma_f32_16x16x32_bf16 v[164:167], v[152:155], v[200:203], v[164:167]
    ds_read_b128 a[108:111], v12 offset:36864
    v_mfma_f32_16x16x32_bf16 v[172:175], v[136:139], v[208:211], v[172:175]
    s_waitcnt lgkmcnt(10)
    v_mfma_f32_16x16x32_bf16 v[160:163], v[132:135], v[196:199], v[160:163]
    ds_read_b128 a[112:115], v13 offset:32768
    s_waitcnt lgkmcnt(7)
    v_mfma_f32_16x16x32_bf16 v[168:171], v[148:151], v[196:199], v[168:171]
    ds_read_b128 a[116:119], v13 offset:36864
    v_mfma_f32_16x16x32_bf16 v[164:167], v[140:143], v[196:199], v[164:167]
    s_waitcnt lgkmcnt(6)
    v_mfma_f32_16x16x32_bf16 v[172:175], v[156:159], v[196:199], v[172:175]
    ds_read_b128 a[120:123], v14 offset:32768
    v_mfma_f32_16x16x32_bf16 v[160:163], v[148:151], v[204:207], v[160:163]
    ds_read_b128 a[124:127], v14 offset:36864
    v_mfma_f32_16x16x32_bf16 v[168:171], v[132:135], v[212:215], v[168:171]
    v_mfma_f32_16x16x32_bf16 v[164:167], v[156:159], v[204:207], v[164:167]
    v_mfma_f32_16x16x32_bf16 v[172:175], v[140:143], v[212:215], v[172:175]
    s_add_u32 s1, s7, 0
    s_and_b32 s1, s1, 1023
    s_add_u32 s1, s1, s79
    s_add_u32 m0, s82, 94208
    s_nop 0
    buffer_load_dwordx4 v113, s[40:43], s1 offen offset:1024 lds
    buffer_load_dwordx4 v114, s[40:43], s1 offen offset:2048 lds
    buffer_load_dwordx4 v115, s[40:43], s1 offen offset:3072 lds
    s_waitcnt lgkmcnt(0)
    s_barrier
    v_pk_mul_f32 v[24:25], v[160:161], v[240:241]
    v_pk_mul_f32 v[32:33], v[168:169], v[240:241]
    v_pk_mul_f32 v[26:27], v[162:163], v[242:243]
    v_pk_mul_f32 v[34:35], v[170:171], v[242:243]
    v_pk_mul_f32 v[28:29], v[164:165], v[244:245]
    v_pk_mul_f32 v[36:37], v[172:173], v[244:245]
    v_pk_mul_f32 v[30:31], v[166:167], v[246:247]
    v_pk_mul_f32 v[38:39], v[174:175], v[246:247]
    v_pk_fma_f32 v[24:25], v[168:169], v[248:249], v[24:25]
    v_pk_fma_f32 v[32:33], v[160:161], v[248:249], v[32:33] neg_lo:[1,0,0] neg_hi:[1,0,0]
    v_pk_fma_f32 v[26:27], v[170:171], v[250:251], v[26:27]
    v_pk_fma_f32 v[34:35], v[162:163], v[250:251], v[34:35] neg_lo:[1,0,0] neg_hi:[1,0,0]
    v_pk_fma_f32 v[28:29], v[172:173], v[252:253], v[28:29]
    v_pk_fma_f32 v[36:37], v[164:165], v[252:253], v[36:37] neg_lo:[1,0,0] neg_hi:[1,0,0]
    v_pk_fma_f32 v[30:31], v[174:175], v[254:255], v[30:31]
    v_pk_fma_f32 v[38:39], v[166:167], v[254:255], v[38:39] neg_lo:[1,0,0] neg_hi:[1,0,0]
    v_cvt_pk_bf16_f32 v176, v24, v25
    v_cvt_pk_bf16_f32 v180, v32, v33
    v_cvt_pk_bf16_f32 v177, v26, v27
    v_cvt_pk_bf16_f32 v181, v34, v35
    v_cvt_pk_bf16_f32 v178, v28, v29
    v_cvt_pk_bf16_f32 v182, v36, v37
    v_cvt_pk_bf16_f32 v179, v30, v31
    v_cvt_pk_bf16_f32 v183, v38, v39
    s_nop 0
    v_mfma_f32_16x16x32_bf16 v[160:163], v[216:219], v[176:179], 0
    v_lshlrev_b32 v48, 16, v184
    v_and_b32 v49, 0xffff0000, v184
    v_mfma_f32_16x16x32_bf16 v[168:171], v[216:219], v[180:183], 0
    v_lshlrev_b32 v50, 16, v185
    v_and_b32 v51, 0xffff0000, v185
    v_mfma_f32_16x16x32_bf16 v[164:167], v[220:223], v[176:179], 0
    v_lshlrev_b32 v52, 16, v186
    v_and_b32 v53, 0xffff0000, v186
    v_mfma_f32_16x16x32_bf16 v[172:175], v[220:223], v[180:183], 0
    v_lshlrev_b32 v54, 16, v187
    v_and_b32 v55, 0xffff0000, v187
    v_mfma_f32_16x16x32_bf16 v[160:163], v[224:227], v[180:183], v[160:163]
    v_lshlrev_b32 v56, 16, v188
    v_and_b32 v57, 0xffff0000, v188
    v_mfma_f32_16x16x32_bf16 v[168:171], v[232:235], v[176:179], v[168:171]
    v_lshlrev_b32 v58, 16, v189
    v_and_b32 v59, 0xffff0000, v189
    v_mfma_f32_16x16x32_bf16 v[164:167], v[228:231], v[180:183], v[164:167]
    v_lshlrev_b32 v60, 16, v190
    v_and_b32 v61, 0xffff0000, v190
    v_mfma_f32_16x16x32_bf16 v[172:175], v[236:239], v[176:179], v[172:175]
    v_lshlrev_b32 v62, 16, v191
    v_and_b32 v63, 0xffff0000, v191
    s_add_u32 s1, s7, 0
    s_and_b32 s1, s1, 1023
    s_add_u32 s1, s1, s79
    s_add_u32 m0, s82, 98304
    s_nop 0
    buffer_load_dwordx4 v116, s[40:43], s1 offen lds
    buffer_load_dwordx4 v117, s[40:43], s1 offen offset:1024 lds
    buffer_load_dwordx4 v118, s[40:43], s1 offen offset:2048 lds
    v_pk_mul_f32 v[24:25], v[160:161], v[48:49]
    v_pk_mul_f32 v[32:33], v[168:169], v[48:49]
    v_pk_mul_f32 v[26:27], v[162:163], v[50:51]
    v_pk_mul_f32 v[34:35], v[170:171], v[50:51]
    v_pk_mul_f32 v[28:29], v[164:165], v[52:53]
    v_pk_mul_f32 v[36:37], v[172:173], v[52:53]
    v_pk_mul_f32 v[30:31], v[166:167], v[54:55]
    v_pk_mul_f32 v[38:39], v[174:175], v[54:55]
    v_pk_fma_f32 v[24:25], v[168:169], v[56:57], v[24:25] neg_lo:[1,0,0] neg_hi:[1,0,0]
    v_pk_fma_f32 v[32:33], v[160:161], v[56:57], v[32:33]
    v_pk_fma_f32 v[26:27], v[170:171], v[58:59], v[26:27] neg_lo:[1,0,0] neg_hi:[1,0,0]
    v_pk_fma_f32 v[34:35], v[162:163], v[58:59], v[34:35]
    v_pk_fma_f32 v[28:29], v[172:173], v[60:61], v[28:29] neg_lo:[1,0,0] neg_hi:[1,0,0]
    v_pk_fma_f32 v[36:37], v[164:165], v[60:61], v[36:37]
    v_pk_fma_f32 v[30:31], v[174:175], v[62:63], v[30:31] neg_lo:[1,0,0] neg_hi:[1,0,0]
    v_pk_fma_f32 v[38:39], v[166:167], v[62:63], v[38:39]
    v_cvt_pk_bf16_f32 v176, v24, v25
    v_cvt_pk_bf16_f32 v180, v32, v33
    v_cvt_pk_bf16_f32 v177, v26, v27
    v_cvt_pk_bf16_f32 v181, v34, v35
    v_cvt_pk_bf16_f32 v178, v28, v29
    v_cvt_pk_bf16_f32 v182, v36, v37
    v_cvt_pk_bf16_f32 v179, v30, v31
    v_cvt_pk_bf16_f32 v183, v38, v39
    s_nop 0
    v_mfma_f32_16x16x32_bf16 v[160:163], v[216:219], v[176:179], 0
    v_and_b32 v1, 31, v0
    v_bfe_u32 v6, v1, 1, 3
    v_mfma_f32_16x16x32_bf16 v[168:171], v[216:219], v[180:183], 0
    v_bfe_u32 v7, v0, 5, 1
    v_xor_b32 v6, v6, v7
    v_mfma_f32_16x16x32_bf16 v[164:167], v[220:223], v[176:179], 0
    v_lshlrev_b32 v6, 4, v6
    v_lshl_add_u32 v1, v1, 7, v6
    v_mfma_f32_16x16x32_bf16 v[172:175], v[220:223], v[180:183], 0
    v_add_u32 v11, s82, v1
    v_xor_b32 v12, 32, v11
    v_mfma_f32_16x16x32_bf16 v[160:163], v[232:235], v[180:183], v[160:163]
    v_xor_b32 v13, 64, v11
    v_xor_b32 v14, 96, v11
    v_mfma_f32_16x16x32_bf16 v[168:171], v[224:227], v[176:179], v[168:171]
    v_add_u32 v104, 90112, v11
    v_add_u32 v105, 90112, v12
    v_mfma_f32_16x16x32_bf16 v[164:167], v[236:239], v[180:183], v[164:167]
    v_add_u32 v106, 90112, v13
    v_add_u32 v107, 90112, v14
    v_mfma_f32_16x16x32_bf16 v[172:175], v[228:231], v[176:179], v[172:175]
    s_add_u32 s1, s7, 128
    s_and_b32 s1, s1, 1023
    s_add_u32 s1, s1, s79
    s_add_u32 m0, s82, 0
    s_nop 0
    buffer_load_dwordx4 v108, s[40:43], s1 offen lds
    buffer_load_dwordx4 v109, s[40:43], s1 offen offset:1024 lds
    buffer_load_dwordx4 v110, s[40:43], s1 offen offset:2048 lds
    v_pk_mul_f32 v[24:25], v[160:161], v[240:241]
    v_pk_mul_f32 v[32:33], v[168:169], v[240:241]
    v_pk_mul_f32 v[26:27], v[162:163], v[242:243]
    v_pk_mul_f32 v[34:35], v[170:171], v[242:243]
    v_pk_mul_f32 v[28:29], v[164:165], v[244:245]
    v_pk_mul_f32 v[36:37], v[172:173], v[244:245]
    v_pk_mul_f32 v[30:31], v[166:167], v[246:247]
    v_pk_mul_f32 v[38:39], v[174:175], v[246:247]
    v_pk_fma_f32 v[24:25], v[168:169], v[248:249], v[24:25] neg_lo:[1,0,0] neg_hi:[1,0,0]
    v_pk_fma_f32 v[32:33], v[160:161], v[248:249], v[32:33]
    v_pk_fma_f32 v[26:27], v[170:171], v[250:251], v[26:27] neg_lo:[1,0,0] neg_hi:[1,0,0]
    v_pk_fma_f32 v[34:35], v[162:163], v[250:251], v[34:35]
    v_pk_fma_f32 v[28:29], v[172:173], v[252:253], v[28:29] neg_lo:[1,0,0] neg_hi:[1,0,0]
    v_pk_fma_f32 v[36:37], v[164:165], v[252:253], v[36:37]
    v_pk_fma_f32 v[30:31], v[174:175], v[254:255], v[30:31] neg_lo:[1,0,0] neg_hi:[1,0,0]
    v_pk_fma_f32 v[38:39], v[166:167], v[254:255], v[38:39]
    v_cvt_pk_bf16_f32 v176, v24, v25
    v_cvt_pk_bf16_f32 v180, v32, v33
    v_cvt_pk_bf16_f32 v177, v26, v27
    v_cvt_pk_bf16_f32 v181, v34, v35
    v_cvt_pk_bf16_f32 v178, v28, v29
    v_cvt_pk_bf16_f32 v182, v36, v37
    v_cvt_pk_bf16_f32 v179, v30, v31
    v_cvt_pk_bf16_f32 v183, v38, v39
    ds_write_b128 v17, v[176:179] offset:0
    ds_write_b128 v17, v[180:183] offset:4096
    s_add_u32 s1, s7, 128
    s_and_b32 s1, s1, 1023
    s_add_u32 s1, s1, s79
    s_add_u32 m0, s82, 0
    s_nop 0
    buffer_load_dwordx4 v111, s[40:43], s1 offen offset:3072 lds
    s_add_u32 m0, s82, 4096
    s_nop 0
    buffer_load_dwordx4 v112, s[40:43], s1 offen lds
    buffer_load_dwordx4 v113, s[40:43], s1 offen offset:1024 lds
    s_waitcnt lgkmcnt(0)
    s_barrier
    ds_read_b64_tr_b16 v[128:129], v16 offset:0
    ds_read_b64_tr_b16 v[130:131], v16 offset:256
    ds_read_b64_tr_b16 v[136:137], v16 offset:8
    ds_read_b64_tr_b16 v[138:139], v16 offset:264
    ds_read_b64_tr_b16 v[144:145], v16 offset:4096
    ds_read_b64_tr_b16 v[146:147], v16 offset:4352
    ds_read_b64_tr_b16 v[152:153], v16 offset:4104
    ds_read_b64_tr_b16 v[154:155], v16 offset:4360
    ds_read_b64_tr_b16 v[132:133], v16 offset:2048
    ds_read_b64_tr_b16 v[134:135], v16 offset:2304
    ds_read_b64_tr_b16 v[140:141], v16 offset:2056
    ds_read_b64_tr_b16 v[142:143], v16 offset:2312
    ds_read_b64_tr_b16 v[148:149], v16 offset:6144
    ds_read_b64_tr_b16 v[150:151], v16 offset:6400
    ds_read_b64_tr_b16 v[156:157], v16 offset:6152
    ds_read_b64_tr_b16 v[158:159], v16 offset:6408
    s_add_u32 s1, s7, 128
    s_and_b32 s1, s1, 1023
    s_add_u32 s1, s1, s79
    s_add_u32 m0, s82, 4096
    s_nop 0
    buffer_load_dwordx4 v114, s[40:43], s1 offen offset:2048 lds
    buffer_load_dwordx4 v115, s[40:43], s1 offen offset:3072 lds
    s_add_u32 m0, s82, 8192
    s_nop 0
    buffer_load_dwordx4 v116, s[40:43], s1 offen lds
    buffer_load_dwordx4 v117, s[40:43], s1 offen offset:1024 lds
    buffer_load_dwordx4 v118, s[40:43], s1 offen offset:2048 lds
    s_waitcnt lgkmcnt(14)
    v_mfma_f32_16x16x32_bf16 v[160:163], v[128:131], v[192:195], 0
    s_waitcnt lgkmcnt(10)
    v_mfma_f32_16x16x32_bf16 v[168:171], v[144:147], v[192:195], 0
    v_mfma_f32_16x16x32_bf16 v[164:167], v[136:139], v[192:195], 0
    s_waitcnt lgkmcnt(8)
    v_mfma_f32_16x16x32_bf16 v[172:175], v[152:155], v[192:195], 0
    v_mfma_f32_16x16x32_bf16 v[160:163], v[144:147], v[208:211], v[160:163]
    v_mfma_f32_16x16x32_bf16 v[168:171], v[128:131], v[200:203], v[168:171]
    v_mfma_f32_16x16x32_bf16 v[164:167], v[152:155], v[208:211], v[164:167]
    v_mfma_f32_16x16x32_bf16 v[172:175], v[136:139], v[200:203], v[172:175]
    s_waitcnt lgkmcnt(6)
    v_mfma_f32_16x16x32_bf16 v[160:163], v[132:135], v[196:199], v[160:163]
    s_waitcnt lgkmcnt(2)
    v_mfma_f32_16x16x32_bf16 v[168:171], v[148:151], v[196:199], v[168:171]
    v_mfma_f32_16x16x32_bf16 v[164:167], v[140:143], v[196:199], v[164:167]
    s_waitcnt lgkmcnt(0)
    v_mfma_f32_16x16x32_bf16 v[172:175], v[156:159], v[196:199], v[172:175]
    v_mfma_f32_16x16x32_bf16 v[160:163], v[148:151], v[212:215], v[160:163]
    v_mfma_f32_16x16x32_bf16 v[168:171], v[132:135], v[204:207], v[168:171]
    v_mfma_f32_16x16x32_bf16 v[164:167], v[156:159], v[212:215], v[164:167]
    v_mfma_f32_16x16x32_bf16 v[172:175], v[140:143], v[204:207], v[172:175]
    s_add_u32 s1, s7, 256
    s_and_b32 s1, s1, 1023
    s_add_u32 s1, s1, s79
    s_add_u32 m0, s82, 45056
    s_nop 0
    buffer_load_dwordx4 v108, s[40:43], s1 offen lds
    buffer_load_dwordx4 v109, s[40:43], s1 offen offset:1024 lds
    buffer_load_dwordx4 v110, s[40:43], s1 offen offset:2048 lds
    buffer_load_dwordx4 v111, s[40:43], s1 offen offset:3072 lds
    s_add_u32 s52, s81, 1
    s_sub_u32 s53, 384, s52
    s_and_b32 s81, s52, 127
    s_cmp_gt_u32 s52, 128
    s_cselect_b32 s81, s53, s81
    s_cselect_b32 s54, 0x80008000, 0
    v_and_b32 v1, 15, v0
    v_lshrrev_b32 v2, 1, v1
    v_xor_b32 v1, s81, v1
    v_and_b32 v1, 1, v1
    v_lshlrev_b32 v1, 6, v1
    v_lshl_add_u32 v1, v2, 16, v1
    v_bfe_u32 v2, v0, 4, 2
    v_lshl_add_u32 v1, v2, 4, v1
    s_lshl_b32 s52, s50, 19
    s_lshl_b32 s53, s81, 8
    s_add_u32 s52, s52, s53
    s_add_u32 s52, s52, 8388608
    v_cvt_pk_bf16_f32 v176, v160, v161
    v_cvt_pk_bf16_f32 v177, v162, v163
    v_cvt_pk_bf16_f32 v178, v164, v165
    v_cvt_pk_bf16_f32 v179, v166, v167
    v_cvt_pk_bf16_f32 v180, v168, v169
    v_cvt_pk_bf16_f32 v181, v170, v171
    v_cvt_pk_bf16_f32 v182, v172, v173
    v_cvt_pk_bf16_f32 v183, v174, v175
    v_xor_b32 v180, s54, v180
    v_xor_b32 v181, s54, v181
    v_xor_b32 v182, s54, v182
    v_xor_b32 v183, s54, v183
    buffer_store_dwordx4 v[176:179], v1, s[40:43], s52 offen offset:0 sc1
    buffer_store_dwordx4 v[180:183], v1, s[40:43], s52 offen offset:128 sc1
    v_and_b32 v1, 31, v0
    v_bfe_u32 v2, v1, 2, 1
    v_lshrrev_b32 v3, 3, v1
    v_and_b32 v1, 3, v1
    v_lshl_add_u32 v1, v2, 4, v1
    v_lshl_add_u32 v1, v3, 2, v1
    s_lshl_b32 s52, s71, 6
    s_lshl_b32 s53, s73, 5
    s_add_u32 s52, s52, s53
    v_add_u32 v1, s52, v1
    v_cvt_f32_u32 v1, v1
    v_mul_f32 v15, 0xbb000000, v1
    v_bfe_u32 v2, v0, 5, 1
    v_cmp_eq_u32 vcc, 0, v2
    v_cvt_f32_u32 v2, v2
    v_mul_f32 v2, 4.0, v2
    v_mul_f32 v16, v15, v2
    v_mul_f32 v17, 0x43000000, v15
    v_cndmask_b32 v17, v16, v17, vcc
    s_mov_b64 s[62:63], vcc
    s_waitcnt vmcnt(17)
    ds_read_b128 v[224:227], v104 offset:0
    ds_read_b128 v[228:231], v104 offset:4096
    ds_read_b128 v[232:235], v104 offset:8192
    s_waitcnt lgkmcnt(2)
    v_mfma_f32_32x32x16_bf16 v[128:143], a[0:3], v[224:227], 0
    ds_read_b128 v[236:239], v105 offset:0
    s_add_u32 s1, s7, 256
    s_and_b32 s1, s1, 1023
    s_add_u32 s1, s1, s79
    s_add_u32 m0, s82, 49152
    v_mfma_f32_32x32x16_bf16 v[176:191], a[4:7], v[224:227], 0
    ds_read_b128 v[240:243], v105 offset:4096
    buffer_load_dwordx4 v112, s[40:43], s1 offen lds
    s_waitcnt lgkmcnt(3)
    v_mfma_f32_32x32x16_bf16 v[144:159], a[0:3], v[228:231], 0
    ds_read_b128 v[244:247], v105 offset:8192
    v_mov_b32 v248, v17
    v_cos_f32 v249, v248
    v_mfma_f32_32x32x16_bf16 v[192:207], a[4:7], v[228:231], 0
    v_sin_f32 v250, v248
    v_fmamk_f32 v251, v15, 0x3f800000, v16
    v_cvt_pk_bf16_f32 v24, v249, v250
    s_waitcnt lgkmcnt(3)
    v_mfma_f32_32x32x16_bf16 v[160:175], a[0:3], v[232:235], 0
    v_cos_f32 v252, v251
    v_sin_f32 v253, v251
    v_mfma_f32_32x32x16_bf16 v[208:223], a[4:7], v[232:235], 0
    buffer_load_dwordx4 v113, s[40:43], s1 offen offset:1024 lds
    v_fmamk_f32 v248, v15, 0x40000000, v16
    v_cvt_pk_bf16_f32 v25, v252, v253
    v_cos_f32 v249, v248
    s_waitcnt lgkmcnt(2)
    v_mfma_f32_32x32x16_bf16 v[128:143], a[8:11], v[236:239], v[128:143]
    ds_read_b128 v[224:227], v106 offset:0
    v_sin_f32 v250, v248
    v_fmamk_f32 v251, v15, 0x40400000, v16
    v_mfma_f32_32x32x16_bf16 v[176:191], a[12:15], v[236:239], v[176:191]
    ds_read_b128 v[228:231], v106 offset:4096
    v_cvt_pk_bf16_f32 v26, v249, v250
    s_waitcnt lgkmcnt(3)
    v_mfma_f32_32x32x16_bf16 v[144:159], a[8:11], v[240:243], v[144:159]
    ds_read_b128 v[232:235], v106 offset:8192
    v_cos_f32 v252, v251
    v_mfma_f32_32x32x16_bf16 v[192:207], a[12:15], v[240:243], v[192:207]
    buffer_load_dwordx4 v114, s[40:43], s1 offen offset:2048 lds
    v_sin_f32 v253, v251
    s_waitcnt lgkmcnt(3)
    v_mfma_f32_32x32x16_bf16 v[160:175], a[8:11], v[244:247], v[160:175]
    v_fmamk_f32 v248, v15, 0x41000000, v16
    v_cvt_pk_bf16_f32 v27, v252, v253
    v_cos_f32 v249, v248
    v_mfma_f32_32x32x16_bf16 v[208:223], a[12:15], v[244:247], v[208:223]
    v_sin_f32 v250, v248
    buffer_load_dwordx4 v115, s[40:43], s1 offen offset:3072 lds
    v_fmamk_f32 v251, v15, 0x41100000, v16
    v_cvt_pk_bf16_f32 v28, v249, v250
    s_waitcnt lgkmcnt(2)
    v_mfma_f32_32x32x16_bf16 v[128:143], a[16:19], v[224:227], v[128:143]
    ds_read_b128 v[236:239], v107 offset:0
    v_cos_f32 v252, v251
    v_mfma_f32_32x32x16_bf16 v[176:191], a[20:23], v[224:227], v[176:191]
    ds_read_b128 v[240:243], v107 offset:4096
    v_sin_f32 v253, v251
    v_fmamk_f32 v248, v15, 0x41200000, v16
    s_waitcnt lgkmcnt(3)
    v_mfma_f32_32x32x16_bf16 v[144:159], a[16:19], v[228:231], v[144:159]
    ds_read_b128 v[244:247], v107 offset:8192
    v_cvt_pk_bf16_f32 v29, v252, v253
    v_cos_f32 v249, v248
    v_mfma_f32_32x32x16_bf16 v[192:207], a[20:23], v[228:231], v[192:207]
    s_add_u32 m0, s82, 53248
    s_nop 0
    buffer_load_dwordx4 v116, s[40:43], s1 offen lds
    s_waitcnt lgkmcnt(3)
    v_mfma_f32_32x32x16_bf16 v[160:175], a[16:19], v[232:235], v[160:175]
    v_sin_f32 v250, v248
    v_fmamk_f32 v251, v15, 0x41300000, v16
    v_cvt_pk_bf16_f32 v30, v249, v250
    v_mfma_f32_32x32x16_bf16 v[208:223], a[20:23], v[232:235], v[208:223]
    v_cos_f32 v252, v251
    v_sin_f32 v253, v251
    v_fmamk_f32 v248, v15, 0x41800000, v16
    buffer_load_dwordx4 v117, s[40:43], s1 offen offset:1024 lds
    s_waitcnt lgkmcnt(2)
    v_mfma_f32_32x32x16_bf16 v[128:143], a[24:27], v[236:239], v[128:143]
    s_waitcnt vmcnt(12)
    ds_read_b128 v[224:227], v11 offset:0
    v_cvt_pk_bf16_f32 v31, v252, v253
    v_cos_f32 v249, v248
    v_mfma_f32_32x32x16_bf16 v[176:191], a[28:31], v[236:239], v[176:191]
    ds_read_b128 v[228:231], v11 offset:4096
    v_sin_f32 v250, v248
    s_waitcnt lgkmcnt(3)
    v_mfma_f32_32x32x16_bf16 v[144:159], a[24:27], v[240:243], v[144:159]
    ds_read_b128 v[232:235], v11 offset:8192
    v_fmamk_f32 v251, v15, 0x41880000, v16
    v_cvt_pk_bf16_f32 v32, v249, v250
    v_mfma_f32_32x32x16_bf16 v[192:207], a[28:31], v[240:243], v[192:207]
    v_cos_f32 v252, v251
    v_sin_f32 v253, v251
    s_waitcnt lgkmcnt(3)
    v_mfma_f32_32x32x16_bf16 v[160:175], a[24:27], v[244:247], v[160:175]
    buffer_load_dwordx4 v118, s[40:43], s1 offen offset:2048 lds
    v_fmamk_f32 v248, v15, 0x41900000, v16
    v_cvt_pk_bf16_f32 v33, v252, v253
    v_mfma_f32_32x32x16_bf16 v[208:223], a[28:31], v[244:247], v[208:223]
    v_cos_f32 v249, v248
    v_sin_f32 v250, v248
    s_nop 0
    v_cvt_pk_bf16_f32 v34, v249, v250
    s_waitcnt lgkmcnt(2)
    v_mfma_f32_32x32x16_bf16 v[128:143], a[32:35], v[224:227], v[128:143]
    ds_read_b128 v[236:239], v12 offset:0
    s_add_u32 s1, s7, 384
    s_and_b32 s1, s1, 1023
    s_add_u32 s1, s1, s79
    s_add_u32 m0, s82, 90112
    v_mfma_f32_32x32x16_bf16 v[176:191], a[36:39], v[224:227], v[176:191]
    ds_read_b128 v[240:243], v12 offset:4096
    buffer_load_dwordx4 v108, s[40:43], s1 offen lds
    v_fmamk_f32 v251, v15, 0x41980000, v16
    s_waitcnt lgkmcnt(3)
    v_mfma_f32_32x32x16_bf16 v[144:159], a[32:35], v[228:231], v[144:159]
    ds_read_b128 v[244:247], v12 offset:8192
    v_cos_f32 v252, v251
    v_sin_f32 v253, v251
    v_mfma_f32_32x32x16_bf16 v[192:207], a[36:39], v[228:231], v[192:207]
    v_fmamk_f32 v248, v15, 0x41c00000, v16
    buffer_load_dwordx4 v109, s[40:43], s1 offen offset:1024 lds
    v_cvt_pk_bf16_f32 v35, v252, v253
    s_waitcnt lgkmcnt(3)
    v_mfma_f32_32x32x16_bf16 v[160:175], a[32:35], v[232:235], v[160:175]
    v_cos_f32 v249, v248
    v_sin_f32 v250, v248
    v_fmamk_f32 v251, v15, 0x41c80000, v16
    v_mfma_f32_32x32x16_bf16 v[208:223], a[36:39], v[232:235], v[208:223]
    buffer_load_dwordx4 v110, s[40:43], s1 offen offset:2048 lds
    v_cvt_pk_bf16_f32 v36, v249, v250
    v_cos_f32 v252, v251
    v_sin_f32 v253, v251
    buffer_load_dwordx4 v111, s[40:43], s1 offen offset:3072 lds
    s_waitcnt lgkmcnt(2)
    v_mfma_f32_32x32x16_bf16 v[128:143], a[40:43], v[236:239], v[128:143]
    ds_read_b128 v[224:227], v13 offset:0
    v_fmamk_f32 v248, v15, 0x41d00000, v16
    v_cvt_pk_bf16_f32 v37, v252, v253
    v_cos_f32 v249, v248
    v_mfma_f32_32x32x16_bf16 v[176:191], a[44:47], v[236:239], v[176:191]
    ds_read_b128 v[228:231], v13 offset:4096
    v_sin_f32 v250, v248
    s_add_u32 m0, s82, 94208
    s_waitcnt lgkmcnt(3)
    v_mfma_f32_32x32x16_bf16 v[144:159], a[40:43], v[240:243], v[144:159]
    ds_read_b128 v[232:235], v13 offset:8192
    buffer_load_dwordx4 v112, s[40:43], s1 offen lds
    v_fmamk_f32 v251, v15, 0x41d80000, v16
    v_mfma_f32_32x32x16_bf16 v[192:207], a[44:47], v[240:243], v[192:207]
    v_cvt_pk_bf16_f32 v38, v249, v250
    v_cos_f32 v252, v251
    v_sin_f32 v253, v251
    s_waitcnt lgkmcnt(3)
    v_mfma_f32_32x32x16_bf16 v[160:175], a[40:43], v[244:247], v[160:175]
    buffer_load_dwordx4 v113, s[40:43], s1 offen offset:1024 lds
    v_fmamk_f32 v248, v15, 0x42000000, v16
    v_cvt_pk_bf16_f32 v39, v252, v253
    v_mfma_f32_32x32x16_bf16 v[208:223], a[44:47], v[244:247], v[208:223]
    v_cos_f32 v249, v248
    v_sin_f32 v250, v248
    buffer_load_dwordx4 v114, s[40:43], s1 offen offset:2048 lds
    s_waitcnt lgkmcnt(2)
    v_mfma_f32_32x32x16_bf16 v[128:143], a[48:51], v[224:227], v[128:143]
    ds_read_b128 v[236:239], v14 offset:0
    v_fmamk_f32 v251, v15, 0x42040000, v16
    v_cvt_pk_bf16_f32 v40, v249, v250
    v_cos_f32 v252, v251
    v_mfma_f32_32x32x16_bf16 v[176:191], a[52:55], v[224:227], v[176:191]
    ds_read_b128 v[240:243], v14 offset:4096
    v_sin_f32 v253, v251
    s_waitcnt lgkmcnt(3)
    v_mfma_f32_32x32x16_bf16 v[144:159], a[48:51], v[228:231], v[144:159]
    ds_read_b128 v[244:247], v14 offset:8192
    buffer_load_dwordx4 v115, s[40:43], s1 offen offset:3072 lds
    v_fmamk_f32 v248, v15, 0x42080000, v16
    v_mfma_f32_32x32x16_bf16 v[192:207], a[52:55], v[228:231], v[192:207]
    v_cvt_pk_bf16_f32 v41, v252, v253
    v_cos_f32 v249, v248
    s_add_u32 m0, s82, 98304
    s_waitcnt lgkmcnt(3)
    v_mfma_f32_32x32x16_bf16 v[160:175], a[48:51], v[232:235], v[160:175]
    buffer_load_dwordx4 v116, s[40:43], s1 offen lds
    v_sin_f32 v250, v248
    v_fmamk_f32 v251, v15, 0x420c0000, v16
    v_mfma_f32_32x32x16_bf16 v[208:223], a[52:55], v[232:235], v[208:223]
    v_cvt_pk_bf16_f32 v42, v249, v250
    v_cos_f32 v252, v251
    buffer_load_dwordx4 v117, s[40:43], s1 offen offset:1024 lds
    v_sin_f32 v253, v251
    s_waitcnt lgkmcnt(2)
    v_mfma_f32_32x32x16_bf16 v[128:143], a[56:59], v[236:239], v[128:143]
    s_waitcnt vmcnt(10)
    ds_read_b128 v[224:227], v11 offset:45056
    v_fmamk_f32 v248, v15, 0x42200000, v16
    v_cvt_pk_bf16_f32 v43, v252, v253
    v_cos_f32 v249, v248
    v_mfma_f32_32x32x16_bf16 v[176:191], a[60:63], v[236:239], v[176:191]
    ds_read_b128 v[228:231], v11 offset:49152
    buffer_load_dwordx4 v118, s[40:43], s1 offen offset:2048 lds
    s_waitcnt lgkmcnt(3)
    v_mfma_f32_32x32x16_bf16 v[144:159], a[56:59], v[240:243], v[144:159]
    ds_read_b128 v[232:235], v11 offset:53248
    v_sin_f32 v250, v248
    v_fmamk_f32 v251, v15, 0x42240000, v16
    v_cvt_pk_bf16_f32 v44, v249, v250
    v_mfma_f32_32x32x16_bf16 v[192:207], a[60:63], v[240:243], v[192:207]
    v_cos_f32 v252, v251
    v_mov_b32 v4, s51
    v_mov_b32 v5, s51
    v_and_b32 v6, 63, v0
    s_waitcnt lgkmcnt(3)
    v_mfma_f32_32x32x16_bf16 v[160:175], a[56:59], v[244:247], v[160:175]
    v_cmp_eq_u32 vcc, 0, v6
    v_mov_b32 v6, 1073741824
    s_lshl_b32 s52, s50, 8
    s_add_u32 s52, s52, s81
    v_cndmask_b32 v6, v6, 0, vcc
    s_lshl_b32 s52, s52, 4
    s_add_u32 s52, s52, 16384
    v_mfma_f32_32x32x16_bf16 v[208:223], a[60:63], v[244:247], v[208:223]
    buffer_store_dwordx2 v[4:5], v6, s[40:43], s52 offen sc1
    v_sin_f32 v253, v251
    s_nop 0
    v_cvt_pk_bf16_f32 v45, v252, v253
    s_waitcnt lgkmcnt(2)
    v_mfma_f32_32x32x16_bf16 v[128:143], a[64:67], v[224:227], v[128:143]
    ds_read_b128 v[236:239], v12 offset:45056
    s_add_u32 s1, s7, 512
    s_and_b32 s1, s1, 1023
    s_add_u32 s1, s1, s79
    s_add_u32 m0, s82, 0
    v_mfma_f32_32x32x16_bf16 v[176:191], a[68:71], v[224:227], v[176:191]
    ds_read_b128 v[240:243], v12 offset:49152
    buffer_load_dwordx4 v108, s[40:43], s1 offen lds
    s_waitcnt lgkmcnt(3)
    v_mfma_f32_32x32x16_bf16 v[144:159], a[64:67], v[228:231], v[144:159]
    ds_read_b128 v[244:247], v12 offset:53248
    v_fmamk_f32 v248, v15, 0x42280000, v16
    v_cos_f32 v249, v248
    v_mfma_f32_32x32x16_bf16 v[192:207], a[68:71], v[228:231], v[192:207]
    v_sin_f32 v250, v248
    v_fmamk_f32 v251, v15, 0x422c0000, v16
    v_cvt_pk_bf16_f32 v46, v249, v250
    s_waitcnt lgkmcnt(3)
    v_mfma_f32_32x32x16_bf16 v[160:175], a[64:67], v[232:235], v[160:175]
    buffer_load_dwordx4 v109, s[40:43], s1 offen offset:1024 lds
    v_cos_f32 v252, v251
    v_mfma_f32_32x32x16_bf16 v[208:223], a[68:71], v[232:235], v[208:223]
    v_sin_f32 v253, v251
    v_fmamk_f32 v248, v15, 0x42400000, v16
    v_cvt_pk_bf16_f32 v47, v252, v253
    buffer_load_dwordx4 v110, s[40:43], s1 offen offset:2048 lds
    v_cos_f32 v249, v248
    s_waitcnt lgkmcnt(2)
    v_mfma_f32_32x32x16_bf16 v[128:143], a[72:75], v[236:239], v[128:143]
    ds_read_b128 v[224:227], v13 offset:45056
    v_sin_f32 v250, v248
    v_fmamk_f32 v251, v15, 0x42440000, v16
    v_mfma_f32_32x32x16_bf16 v[176:191], a[76:79], v[236:239], v[176:191]
    ds_read_b128 v[228:231], v13 offset:49152
    v_cvt_pk_bf16_f32 v48, v249, v250
    s_waitcnt lgkmcnt(3)
    v_mfma_f32_32x32x16_bf16 v[144:159], a[72:75], v[240:243], v[144:159]
    ds_read_b128 v[232:235], v13 offset:53248
    buffer_load_dwordx4 v111, s[40:43], s1 offen offset:3072 lds
    v_mfma_f32_32x32x16_bf16 v[192:207], a[76:79], v[240:243], v[192:207]
    v_cos_f32 v252, v251
    v_sin_f32 v253, v251
    v_fmamk_f32 v248, v15, 0x42480000, v16
    s_waitcnt lgkmcnt(3)
    v_mfma_f32_32x32x16_bf16 v[160:175], a[72:75], v[244:247], v[160:175]
    v_cvt_pk_bf16_f32 v49, v252, v253
    s_add_u32 m0, s82, 4096
    s_nop 0
    buffer_load_dwordx4 v112, s[40:43], s1 offen lds
    v_mfma_f32_32x32x16_bf16 v[208:223], a[76:79], v[244:247], v[208:223]
    v_cos_f32 v249, v248
    v_sin_f32 v250, v248
    v_fmamk_f32 v251, v15, 0x424c0000, v16
    v_cvt_pk_bf16_f32 v50, v249, v250
    buffer_load_dwordx4 v113, s[40:43], s1 offen offset:1024 lds
    s_waitcnt lgkmcnt(2)
    v_mfma_f32_32x32x16_bf16 v[128:143], a[80:83], v[224:227], v[128:143]
    ds_read_b128 v[236:239], v14 offset:45056
    v_cos_f32 v252, v251
    v_sin_f32 v253, v251
    v_mfma_f32_32x32x16_bf16 v[176:191], a[84:87], v[224:227], v[176:191]
    ds_read_b128 v[240:243], v14 offset:49152
    v_fmamk_f32 v248, v15, 0x42600000, v16
    v_cvt_pk_bf16_f32 v51, v252, v253
    s_waitcnt lgkmcnt(3)
    v_mfma_f32_32x32x16_bf16 v[144:159], a[80:83], v[228:231], v[144:159]
    ds_read_b128 v[244:247], v14 offset:53248
    buffer_load_dwordx4 v114, s[40:43], s1 offen offset:2048 lds
    v_mfma_f32_32x32x16_bf16 v[192:207], a[84:87], v[228:231], v[192:207]
    v_cos_f32 v249, v248
    v_sin_f32 v250, v248
    v_fmamk_f32 v251, v15, 0x42640000, v16
    v_cvt_pk_bf16_f32 v52, v249, v250
    s_waitcnt lgkmcnt(3)
    v_mfma_f32_32x32x16_bf16 v[160:175], a[80:83], v[232:235], v[160:175]
    buffer_load_dwordx4 v115, s[40:43], s1 offen offset:3072 lds
    v_cos_f32 v252, v251
    v_mfma_f32_32x32x16_bf16 v[208:223], a[84:87], v[232:235], v[208:223]
    v_sin_f32 v253, v251
    v_fmamk_f32 v248, v15, 0x42680000, v16
    v_cvt_pk_bf16_f32 v53, v252, v253
    s_add_u32 m0, s82, 8192
    s_nop 0
    buffer_load_dwordx4 v116, s[40:43], s1 offen lds
    s_waitcnt lgkmcnt(2)
    v_mfma_f32_32x32x16_bf16 v[128:143], a[88:91], v[236:239], v[128:143]
    s_waitcnt vmcnt(10)
    ds_read_b128 v[224:227], v104 offset:0
    v_cos_f32 v249, v248
    v_mfma_f32_32x32x16_bf16 v[176:191], a[92:95], v[236:239], v[176:191]
    ds_read_b128 v[228:231], v104 offset:4096
    v_sin_f32 v250, v248
    v_fmamk_f32 v251, v15, 0x426c0000, v16
    s_waitcnt lgkmcnt(3)
    v_mfma_f32_32x32x16_bf16 v[144:159], a[88:91], v[240:243], v[144:159]
    ds_read_b128 v[232:235], v104 offset:8192
    v_cvt_pk_bf16_f32 v54, v249, v250
    v_mfma_f32_32x32x16_bf16 v[192:207], a[92:95], v[240:243], v[192:207]
    buffer_load_dwordx4 v117, s[40:43], s1 offen offset:1024 lds
    v_cos_f32 v252, v251
    s_waitcnt lgkmcnt(3)
    v_mfma_f32_32x32x16_bf16 v[160:175], a[88:91], v[244:247], v[160:175]
    v_sin_f32 v253, v251
    v_fmamk_f32 v248, v15, 0x42800000, v16
    v_cvt_pk_bf16_f32 v55, v252, v253
    v_mfma_f32_32x32x16_bf16 v[208:223], a[92:95], v[244:247], v[208:223]
    buffer_load_dwordx4 v118, s[40:43], s1 offen offset:2048 lds
    v_cos_f32 v249, v248
    v_sin_f32 v250, v248
    s_nop 0
    v_cvt_pk_bf16_f32 v56, v249, v250
    s_waitcnt lgkmcnt(2)
    v_mfma_f32_32x32x16_bf16 v[128:143], a[96:99], v[224:227], v[128:143]
    ds_read_b128 v[236:239], v105 offset:0
    s_add_u32 s1, s7, 640
    s_and_b32 s1, s1, 1023
    s_add_u32 s1, s1, s79
    s_add_u32 m0, s82, 45056
    v_mfma_f32_32x32x16_bf16 v[176:191], a[100:103], v[224:227], v[176:191]
    ds_read_b128 v[240:243], v105 offset:4096
    buffer_load_dwordx4 v108, s[40:43], s1 offen lds
    s_waitcnt lgkmcnt(3)
    v_mfma_f32_32x32x16_bf16 v[144:159], a[96:99], v[228:231], v[144:159]
    ds_read_b128 v[244:247], v105 offset:8192
    v_fmamk_f32 v251, v15, 0x42820000, v16
    v_cos_f32 v252, v251
    v_mfma_f32_32x32x16_bf16 v[192:207], a[100:103], v[228:231], v[192:207]
    v_sin_f32 v253, v251
    v_fmamk_f32 v248, v15, 0x42840000, v16
    v_cvt_pk_bf16_f32 v57, v252, v253
    s_waitcnt lgkmcnt(3)
    v_mfma_f32_32x32x16_bf16 v[160:175], a[96:99], v[232:235], v[160:175]
    buffer_load_dwordx4 v109, s[40:43], s1 offen offset:1024 lds
    v_cos_f32 v249, v248
    v_mfma_f32_32x32x16_bf16 v[208:223], a[100:103], v[232:235], v[208:223]
    v_sin_f32 v250, v248
    v_fmamk_f32 v251, v15, 0x42860000, v16
    v_cvt_pk_bf16_f32 v58, v249, v250
    buffer_load_dwordx4 v110, s[40:43], s1 offen offset:2048 lds
    v_cos_f32 v252, v251
    s_waitcnt lgkmcnt(2)
    v_mfma_f32_32x32x16_bf16 v[128:143], a[104:107], v[236:239], v[128:143]
    ds_read_b128 v[224:227], v106 offset:0
    v_sin_f32 v253, v251
    v_fmamk_f32 v248, v15, 0x42900000, v16
    v_mfma_f32_32x32x16_bf16 v[176:191], a[108:111], v[236:239], v[176:191]
    ds_read_b128 v[228:231], v106 offset:4096
    v_cvt_pk_bf16_f32 v59, v252, v253
    s_waitcnt lgkmcnt(3)
    v_mfma_f32_32x32x16_bf16 v[144:159], a[104:107], v[240:243], v[144:159]
    ds_read_b128 v[232:235], v106 offset:8192
    buffer_load_dwordx4 v111, s[40:43], s1 offen offset:3072 lds
    v_mfma_f32_32x32x16_bf16 v[192:207], a[108:111], v[240:243], v[192:207]
    v_cos_f32 v249, v248
    v_sin_f32 v250, v248
    v_fmamk_f32 v251, v15, 0x42920000, v16
    s_waitcnt lgkmcnt(3)
    v_mfma_f32_32x32x16_bf16 v[160:175], a[104:107], v[244:247], v[160:175]
    v_cvt_pk_bf16_f32 v60, v249, v250
    s_add_u32 m0, s82, 49152
    s_nop 0
    buffer_load_dwordx4 v112, s[40:43], s1 offen lds
    v_mfma_f32_32x32x16_bf16 v[208:223], a[108:111], v[244:247], v[208:223]
    v_cos_f32 v252, v251
    v_sin_f32 v253, v251
    v_fmamk_f32 v248, v15, 0x42940000, v16
    v_cvt_pk_bf16_f32 v61, v252, v253
    buffer_load_dwordx4 v113, s[40:43], s1 offen offset:1024 lds
    s_waitcnt lgkmcnt(2)
    v_mfma_f32_32x32x16_bf16 v[128:143], a[112:115], v[224:227], v[128:143]
    ds_read_b128 v[236:239], v107 offset:0
    v_cos_f32 v249, v248
    v_sin_f32 v250, v248
    v_mfma_f32_32x32x16_bf16 v[176:191], a[116:119], v[224:227], v[176:191]
    ds_read_b128 v[240:243], v107 offset:4096
    v_fmamk_f32 v251, v15, 0x42960000, v16
    v_cvt_pk_bf16_f32 v62, v249, v250
    s_waitcnt lgkmcnt(3)
    v_mfma_f32_32x32x16_bf16 v[144:159], a[112:115], v[228:231], v[144:159]
    ds_read_b128 v[244:247], v107 offset:8192
    buffer_load_dwordx4 v114, s[40:43], s1 offen offset:2048 lds
    v_mfma_f32_32x32x16_bf16 v[192:207], a[116:119], v[228:231], v[192:207]
    v_cos_f32 v252, v251
    v_sin_f32 v253, v251
    v_fmamk_f32 v248, v15, 0x42a00000, v16
    v_cvt_pk_bf16_f32 v63, v252, v253
    s_waitcnt lgkmcnt(3)
    v_mfma_f32_32x32x16_bf16 v[160:175], a[112:115], v[232:235], v[160:175]
    buffer_load_dwordx4 v115, s[40:43], s1 offen offset:3072 lds
    v_cos_f32 v249, v248
    v_mfma_f32_32x32x16_bf16 v[208:223], a[116:119], v[232:235], v[208:223]
    v_sin_f32 v250, v248
    v_fmamk_f32 v251, v15, 0x42a20000, v16
    v_cvt_pk_bf16_f32 v64, v249, v250
    s_add_u32 m0, s82, 53248
    s_nop 0
    buffer_load_dwordx4 v116, s[40:43], s1 offen lds
    s_waitcnt lgkmcnt(2)
    v_mfma_f32_32x32x16_bf16 v[128:143], a[120:123], v[236:239], v[128:143]
    s_waitcnt vmcnt(9)
    ds_read_b128 v[224:227], v11 offset:0
    v_cos_f32 v252, v251
    v_mfma_f32_32x32x16_bf16 v[176:191], a[124:127], v[236:239], v[176:191]
    ds_read_b128 v[228:231], v11 offset:4096
    v_sin_f32 v253, v251
    v_fmamk_f32 v248, v15, 0x42a40000, v16
    s_waitcnt lgkmcnt(3)
    v_mfma_f32_32x32x16_bf16 v[144:159], a[120:123], v[240:243], v[144:159]
    ds_read_b128 v[232:235], v11 offset:8192
    v_cvt_pk_bf16_f32 v65, v252, v253
    v_mfma_f32_32x32x16_bf16 v[192:207], a[124:127], v[240:243], v[192:207]
    buffer_load_dwordx4 v117, s[40:43], s1 offen offset:1024 lds
    v_cos_f32 v249, v248
    s_waitcnt lgkmcnt(3)
    v_mfma_f32_32x32x16_bf16 v[160:175], a[120:123], v[244:247], v[160:175]
    v_sin_f32 v250, v248
    v_fmamk_f32 v251, v15, 0x42a60000, v16
    v_cvt_pk_bf16_f32 v66, v249, v250
    v_mfma_f32_32x32x16_bf16 v[208:223], a[124:127], v[244:247], v[208:223]
    buffer_load_dwordx4 v118, s[40:43], s1 offen offset:2048 lds
    v_cos_f32 v252, v251
    v_sin_f32 v253, v251
    s_nop 0
    v_cvt_pk_bf16_f32 v67, v252, v253
    s_waitcnt lgkmcnt(2)
    v_mfma_f32_32x32x16_bf16 v[128:143], a[128:131], v[224:227], v[128:143]
    ds_read_b128 v[236:239], v12 offset:0
    s_add_u32 s1, s7, 768
    s_and_b32 s1, s1, 1023
    s_add_u32 s1, s1, s79
    s_add_u32 m0, s82, 90112
    v_mfma_f32_32x32x16_bf16 v[176:191], a[132:135], v[224:227], v[176:191]
    ds_read_b128 v[240:243], v12 offset:4096
    buffer_load_dwordx4 v108, s[40:43], s1 offen lds
    s_waitcnt lgkmcnt(3)
    v_mfma_f32_32x32x16_bf16 v[144:159], a[128:131], v[228:231], v[144:159]
    ds_read_b128 v[244:247], v12 offset:8192
    v_fmamk_f32 v248, v15, 0x42b00000, v16
    v_cos_f32 v249, v248
    v_mfma_f32_32x32x16_bf16 v[192:207], a[132:135], v[228:231], v[192:207]
    v_sin_f32 v250, v248
    v_fmamk_f32 v251, v15, 0x42b20000, v16
    v_cvt_pk_bf16_f32 v68, v249, v250
    s_waitcnt lgkmcnt(3)
    v_mfma_f32_32x32x16_bf16 v[160:175], a[128:131], v[232:235], v[160:175]
    buffer_load_dwordx4 v109, s[40:43], s1 offen offset:1024 lds
    v_cos_f32 v252, v251
    v_mfma_f32_32x32x16_bf16 v[208:223], a[132:135], v[232:235], v[208:223]
    v_sin_f32 v253, v251
    v_fmamk_f32 v248, v15, 0x42b40000, v16
    v_cvt_pk_bf16_f32 v69, v252, v253
    buffer_load_dwordx4 v110, s[40:43], s1 offen offset:2048 lds
    v_cos_f32 v249, v248
    s_waitcnt lgkmcnt(2)
    v_mfma_f32_32x32x16_bf16 v[128:143], a[136:139], v[236:239], v[128:143]
    ds_read_b128 v[224:227], v13 offset:0
    v_sin_f32 v250, v248
    v_fmamk_f32 v251, v15, 0x42b60000, v16
    v_mfma_f32_32x32x16_bf16 v[176:191], a[140:143], v[236:239], v[176:191]
    ds_read_b128 v[228:231], v13 offset:4096
    v_cvt_pk_bf16_f32 v70, v249, v250
    s_waitcnt lgkmcnt(3)
    v_mfma_f32_32x32x16_bf16 v[144:159], a[136:139], v[240:243], v[144:159]
    ds_read_b128 v[232:235], v13 offset:8192
    buffer_load_dwordx4 v111, s[40:43], s1 offen offset:3072 lds
    v_mfma_f32_32x32x16_bf16 v[192:207], a[140:143], v[240:243], v[192:207]
    v_cos_f32 v252, v251
    v_sin_f32 v253, v251
    v_fmamk_f32 v248, v15, 0x42c00000, v16
    s_waitcnt lgkmcnt(3)
    v_mfma_f32_32x32x16_bf16 v[160:175], a[136:139], v[244:247], v[160:175]
    v_cvt_pk_bf16_f32 v71, v252, v253
    s_add_u32 m0, s82, 94208
    s_nop 0
    buffer_load_dwordx4 v112, s[40:43], s1 offen lds
    v_mfma_f32_32x32x16_bf16 v[208:223], a[140:143], v[244:247], v[208:223]
    v_cos_f32 v249, v248
    v_sin_f32 v250, v248
    v_fmamk_f32 v251, v15, 0x42c20000, v16
    v_cvt_pk_bf16_f32 v72, v249, v250
    buffer_load_dwordx4 v113, s[40:43], s1 offen offset:1024 lds
    s_waitcnt lgkmcnt(2)
    v_mfma_f32_32x32x16_bf16 v[128:143], a[144:147], v[224:227], v[128:143]
    ds_read_b128 v[236:239], v14 offset:0
    v_cos_f32 v252, v251
    v_sin_f32 v253, v251
    v_mfma_f32_32x32x16_bf16 v[176:191], a[148:151], v[224:227], v[176:191]
    ds_read_b128 v[240:243], v14 offset:4096
    v_fmamk_f32 v248, v15, 0x42c40000, v16
    v_cvt_pk_bf16_f32 v73, v252, v253
    s_waitcnt lgkmcnt(3)
    v_mfma_f32_32x32x16_bf16 v[144:159], a[144:147], v[228:231], v[144:159]
    ds_read_b128 v[244:247], v14 offset:8192
    buffer_load_dwordx4 v114, s[40:43], s1 offen offset:2048 lds
    v_mfma_f32_32x32x16_bf16 v[192:207], a[148:151], v[228:231], v[192:207]
    v_cos_f32 v249, v248
    v_sin_f32 v250, v248
    v_fmamk_f32 v251, v15, 0x42c60000, v16
    v_cvt_pk_bf16_f32 v74, v249, v250
    s_waitcnt lgkmcnt(3)
    v_mfma_f32_32x32x16_bf16 v[160:175], a[144:147], v[232:235], v[160:175]
    buffer_load_dwordx4 v115, s[40:43], s1 offen offset:3072 lds
    v_cos_f32 v252, v251
    v_mfma_f32_32x32x16_bf16 v[208:223], a[148:151], v[232:235], v[208:223]
    v_sin_f32 v253, v251
    v_fmamk_f32 v248, v15, 0x42d00000, v16
    v_cvt_pk_bf16_f32 v75, v252, v253
    s_add_u32 m0, s82, 98304
    s_nop 0
    buffer_load_dwordx4 v116, s[40:43], s1 offen lds
    s_waitcnt lgkmcnt(2)
    v_mfma_f32_32x32x16_bf16 v[128:143], a[152:155], v[236:239], v[128:143]
    s_waitcnt vmcnt(9)
    ds_read_b128 v[224:227], v11 offset:45056
    v_cos_f32 v249, v248
    v_mfma_f32_32x32x16_bf16 v[176:191], a[156:159], v[236:239], v[176:191]
    ds_read_b128 v[228:231], v11 offset:49152
    v_sin_f32 v250, v248
    v_fmamk_f32 v251, v15, 0x42d20000, v16
    s_waitcnt lgkmcnt(3)
    v_mfma_f32_32x32x16_bf16 v[144:159], a[152:155], v[240:243], v[144:159]
    ds_read_b128 v[232:235], v11 offset:53248
    v_cvt_pk_bf16_f32 v76, v249, v250
    v_mfma_f32_32x32x16_bf16 v[192:207], a[156:159], v[240:243], v[192:207]
    buffer_load_dwordx4 v117, s[40:43], s1 offen offset:1024 lds
    v_cos_f32 v252, v251
    s_waitcnt lgkmcnt(3)
    v_mfma_f32_32x32x16_bf16 v[160:175], a[152:155], v[244:247], v[160:175]
    v_sin_f32 v253, v251
    v_fmamk_f32 v248, v15, 0x42d40000, v16
    v_cvt_pk_bf16_f32 v77, v252, v253
    v_mfma_f32_32x32x16_bf16 v[208:223], a[156:159], v[244:247], v[208:223]
    buffer_load_dwordx4 v118, s[40:43], s1 offen offset:2048 lds
    v_cos_f32 v249, v248
    v_sin_f32 v250, v248
    s_nop 0
    v_cvt_pk_bf16_f32 v78, v249, v250
    s_waitcnt lgkmcnt(2)
    v_mfma_f32_32x32x16_bf16 v[128:143], a[160:163], v[224:227], v[128:143]
    ds_read_b128 v[236:239], v12 offset:45056
    s_add_u32 s1, s7, 896
    s_and_b32 s1, s1, 1023
    s_add_u32 s1, s1, s79
    s_add_u32 m0, s82, 0
    v_mfma_f32_32x32x16_bf16 v[176:191], a[164:167], v[224:227], v[176:191]
    ds_read_b128 v[240:243], v12 offset:49152
    buffer_load_dwordx4 v108, s[40:43], s1 offen lds
    v_fmamk_f32 v251, v15, 0x42d60000, v16
    s_waitcnt lgkmcnt(3)
    v_mfma_f32_32x32x16_bf16 v[144:159], a[160:163], v[228:231], v[144:159]
    ds_read_b128 v[244:247], v12 offset:53248
    v_cos_f32 v252, v251
    v_sin_f32 v253, v251
    v_mfma_f32_32x32x16_bf16 v[192:207], a[164:167], v[228:231], v[192:207]
    buffer_load_dwordx4 v109, s[40:43], s1 offen offset:1024 lds
    v_fmamk_f32 v248, v15, 0x42e00000, v16
    v_cvt_pk_bf16_f32 v79, v252, v253
    s_waitcnt lgkmcnt(3)
    v_mfma_f32_32x32x16_bf16 v[160:175], a[160:163], v[232:235], v[160:175]
    v_cos_f32 v249, v248
    v_sin_f32 v250, v248
    v_mfma_f32_32x32x16_bf16 v[208:223], a[164:167], v[232:235], v[208:223]
    buffer_load_dwordx4 v110, s[40:43], s1 offen offset:2048 lds
    v_fmamk_f32 v251, v15, 0x42e20000, v16
    v_cvt_pk_bf16_f32 v80, v249, v250
    v_cos_f32 v252, v251
    buffer_load_dwordx4 v111, s[40:43], s1 offen offset:3072 lds
    s_waitcnt lgkmcnt(2)
    v_mfma_f32_32x32x16_bf16 v[128:143], a[168:171], v[236:239], v[128:143]
    ds_read_b128 v[224:227], v13 offset:45056
    v_sin_f32 v253, v251
    v_fmamk_f32 v248, v15, 0x42e40000, v16
    v_cvt_pk_bf16_f32 v81, v252, v253
    v_mfma_f32_32x32x16_bf16 v[176:191], a[172:175], v[236:239], v[176:191]
    ds_read_b128 v[228:231], v13 offset:49152
    s_add_u32 m0, s82, 4096
    s_nop 0
    buffer_load_dwordx4 v112, s[40:43], s1 offen lds
    s_waitcnt lgkmcnt(3)
    v_mfma_f32_32x32x16_bf16 v[144:159], a[168:171], v[240:243], v[144:159]
    ds_read_b128 v[232:235], v13 offset:53248
    v_cos_f32 v249, v248
    v_mfma_f32_32x32x16_bf16 v[192:207], a[172:175], v[240:243], v[192:207]
    v_sin_f32 v250, v248
    buffer_load_dwordx4 v113, s[40:43], s1 offen offset:1024 lds
    v_fmamk_f32 v251, v15, 0x42e60000, v16
    s_waitcnt lgkmcnt(3)
    v_mfma_f32_32x32x16_bf16 v[160:175], a[168:171], v[244:247], v[160:175]
    v_cvt_pk_bf16_f32 v82, v249, v250
    v_cos_f32 v252, v251
    v_sin_f32 v253, v251
    v_mfma_f32_32x32x16_bf16 v[208:223], a[172:175], v[244:247], v[208:223]
    buffer_load_dwordx4 v114, s[40:43], s1 offen offset:2048 lds
    v_fmamk_f32 v248, v15, 0x42f00000, v16
    v_cvt_pk_bf16_f32 v83, v252, v253
    v_cos_f32 v249, v248
    s_waitcnt lgkmcnt(2)
    v_mfma_f32_32x32x16_bf16 v[128:143], a[176:179], v[224:227], v[128:143]
    ds_read_b128 v[236:239], v14 offset:45056
    buffer_load_dwordx4 v115, s[40:43], s1 offen offset:3072 lds
    v_mfma_f32_32x32x16_bf16 v[176:191], a[180:183], v[224:227], v[176:191]
    ds_read_b128 v[240:243], v14 offset:49152
    v_sin_f32 v250, v248
    v_fmamk_f32 v251, v15, 0x42f20000, v16
    s_waitcnt lgkmcnt(3)
    v_mfma_f32_32x32x16_bf16 v[144:159], a[176:179], v[228:231], v[144:159]
    ds_read_b128 v[244:247], v14 offset:53248
    v_cvt_pk_bf16_f32 v84, v249, v250
    s_add_u32 m0, s82, 8192
    v_mfma_f32_32x32x16_bf16 v[192:207], a[180:183], v[228:231], v[192:207]
    buffer_load_dwordx4 v116, s[40:43], s1 offen lds
    v_cos_f32 v252, v251
    s_waitcnt lgkmcnt(3)
    v_mfma_f32_32x32x16_bf16 v[160:175], a[176:179], v[232:235], v[160:175]
    v_sin_f32 v253, v251
    v_fmamk_f32 v248, v15, 0x42f40000, v16
    v_mfma_f32_32x32x16_bf16 v[208:223], a[180:183], v[232:235], v[208:223]
    buffer_load_dwordx4 v117, s[40:43], s1 offen offset:1024 lds
    v_cvt_pk_bf16_f32 v85, v252, v253
    v_cos_f32 v249, v248
    v_sin_f32 v250, v248
    buffer_load_dwordx4 v118, s[40:43], s1 offen offset:2048 lds
    s_waitcnt lgkmcnt(2)
    v_mfma_f32_32x32x16_bf16 v[128:143], a[184:187], v[236:239], v[128:143]
    s_waitcnt vmcnt(11)
    ds_read_b128 v[224:227], v104 offset:0
    v_fmamk_f32 v251, v15, 0x42f60000, v16
    v_cvt_pk_bf16_f32 v86, v249, v250
    v_cos_f32 v252, v251
    v_mfma_f32_32x32x16_bf16 v[176:191], a[188:191], v[236:239], v[176:191]
    ds_read_b128 v[228:231], v104 offset:4096
    v_and_b32 v7, 63, v0
    v_lshlrev_b32 v10, 4, v7
    s_lshr_b32 s80, s70, 3
    s_lshl_b32 s80, s80, 2
    s_add_u32 s80, s80, s50
    s_waitcnt lgkmcnt(3)
    v_mfma_f32_32x32x16_bf16 v[144:159], a[184:187], v[240:243], v[144:159]
    ds_read_b128 v[232:235], v104 offset:8192
    s_lshl_b32 s80, s80, 10
    s_add_u32 s80, s80, 16384
    v_mfma_f32_32x32x16_bf16 v[192:207], a[188:191], v[240:243], v[192:207]
    buffer_load_dwordx2 v[18:19], v10, s[40:43], s80 offen sc1
    v_mov_b32 v5, 1073741824
    s_lshl_b32 s75, s71, 7
    v_bfe_u32 v1, v0, 3, 3
    s_waitcnt lgkmcnt(3)
    v_mfma_f32_32x32x16_bf16 v[160:175], a[184:187], v[244:247], v[160:175]
    v_and_b32 v2, 7, v0
    v_bfe_u32 v3, v0, 4, 1
    v_lshlrev_b32 v3, 2, v3
    v_xor_b32 v2, v2, v3
    v_lshlrev_b32 v2, 4, v2
    v_lshl_add_u32 v8, v1, 10, v2
    v_mfma_f32_32x32x16_bf16 v[208:223], a[188:191], v[244:247], v[208:223]
    v_lshlrev_b32 v6, 7, v7
    s_mul_i32 s55, s50, 90112
    s_add_u32 s55, s55, s75
    s_lshl_b32 s52, s50, 13
    s_add_u32 s75, s75, s52
    s_lshl_b32 s76, s50, 10
    v_sin_f32 v253, v251
    s_nop 0
    v_cvt_pk_bf16_f32 v87, v252, v253
    s_waitcnt lgkmcnt(2)
    v_mfma_f32_32x32x16_bf16 v[128:143], a[192:195], v[224:227], v[128:143]
    ds_read_b128 v[236:239], v105 offset:0
    v_cmp_gt_u32 vcc, 16, v7
    s_lshl_b32 s77, s70, 16
    s_add_u32 s77, s77, 8388608
    s_lshl_b32 s53, s50, 14
    v_cndmask_b32 v126, v5, v6, vcc
    s_lshl_b32 s68, s71, 11
    v_mfma_f32_32x32x16_bf16 v[176:191], a[196:199], v[224:227], v[176:191]
    ds_read_b128 v[240:243], v105 offset:4096
    s_add_u32 s68, s68, s77
    s_add_u32 s68, s68, s53
    s_add_u32 s77, s77, s76
    v_and_b32 v6, 31, v0
    v_bfe_u32 v7, v0, 5, 1
    s_waitcnt lgkmcnt(3)
    v_mfma_f32_32x32x16_bf16 v[144:159], a[192:195], v[228:231], v[144:159]
    ds_read_b128 v[244:247], v105 offset:8192
    v_bfe_u32 v2, v0, 4, 2
    v_xor_b32 v2, v2, v0
    v_and_b32 v2, 3, v2
    v_lshlrev_b32 v2, 4, v2
    v_mfma_f32_32x32x16_bf16 v[192:207], a[196:199], v[228:231], v[192:207]
    v_bfe_u32 v9, v0, 2, 4
    v_lshl_add_u32 v9, v9, 10, v2
    s_lshl_b32 s74, s70, 16
    s_lshl_b32 s53, s72, 15
    s_add_u32 s74, s74, s53
    s_lshl_b32 s53, s71, 7
    s_add_u32 m0, s82, 45056
    s_add_u32 s83, s55, 0
    s_waitcnt lgkmcnt(3)
    v_mfma_f32_32x32x16_bf16 v[160:175], a[192:195], v[232:235], v[160:175]
    buffer_load_dwordx4 v8, s[32:35], s83 offen lds
    s_add_u32 s74, s74, s53
    s_lshl_b32 s53, s73, 6
    s_add_u32 s74, s74, s53
    v_add_u32 v2, 90112, v10
    v_mfma_f32_32x32x16_bf16 v[208:223], a[196:199], v[232:235], v[208:223]
    v_add_u32 v1, s82, v2
    s_xor_b32 s52, s50, 1
    s_mul_i32 s52, s52, 11264
    s_add_u32 m0, s82, 46080
    s_add_u32 s83, s55, 8192
    buffer_load_dwordx4 v8, s[32:35], s83 offen lds
    s_waitcnt lgkmcnt(2)
    v_mfma_f32_32x32x16_bf16 v[128:143], a[200:203], v[236:239], v[128:143]
    ds_read_b128 v[224:227], v106 offset:0
    v_add_u32 v3, s52, v2
    s_xor_b32 s52, s50, 2
    s_mul_i32 s52, s52, 11264
    v_add_u32 v4, s52, v2
    s_xor_b32 s52, s50, 3
    v_mfma_f32_32x32x16_bf16 v[176:191], a[204:207], v[236:239], v[176:191]
    ds_read_b128 v[228:231], v106 offset:4096
    s_mul_i32 s52, s52, 11264
    v_add_u32 v5, s52, v2
    s_add_u32 m0, s82, 47104
    s_add_u32 s83, s55, 16384
    s_waitcnt lgkmcnt(3)
    v_mfma_f32_32x32x16_bf16 v[144:159], a[200:203], v[240:243], v[144:159]
    ds_read_b128 v[232:235], v106 offset:8192
    buffer_load_dwordx4 v8, s[32:35], s83 offen lds
    v_mfma_f32_32x32x16_bf16 v[192:207], a[204:207], v[240:243], v[192:207]
    v_mul_u32_u24 v6, 144, v6
    v_lshl_add_u32 v6, v7, 3, v6
    s_lshl_b32 s52, s50, 4
    s_add_u32 s52, s52, 150016
    v_add_u32 v6, s52, v6
    v_lshlrev_b32 v108, 16, v120
    s_waitcnt lgkmcnt(3)
    v_mfma_f32_32x32x16_bf16 v[160:175], a[200:203], v[244:247], v[160:175]
    v_and_b32 v109, 0xffff0000, v120
    s_add_u32 m0, s82, 48128
    s_add_u32 s83, s55, 24576
    buffer_load_dwordx4 v8, s[32:35], s83 offen lds
    v_mfma_f32_32x32x16_bf16 v[208:223], a[204:207], v[244:247], v[208:223]
    v_lshlrev_b32 v110, 16, v121
    v_and_b32 v111, 0xffff0000, v121
    v_lshlrev_b32 v112, 16, v122
    v_and_b32 v113, 0xffff0000, v122
    v_lshlrev_b32 v114, 16, v123
    v_and_b32 v115, 0xffff0000, v123
    s_waitcnt lgkmcnt(2)
    v_mfma_f32_32x32x16_bf16 v[128:143], a[208:211], v[224:227], v[128:143]
    ds_read_b128 v[236:239], v107 offset:0
    v_lshrrev_b32 v116, 4, v0
    s_add_u32 m0, s82, 49152
    s_add_u32 s83, s55, 32768
    v_mfma_f32_32x32x16_bf16 v[176:191], a[212:215], v[224:227], v[176:191]
    ds_read_b128 v[240:243], v107 offset:4096
    buffer_load_dwordx4 v8, s[32:35], s83 offen lds
    s_waitcnt lgkmcnt(3)
    v_mfma_f32_32x32x16_bf16 v[144:159], a[208:211], v[228:231], v[144:159]
    ds_read_b128 v[244:247], v107 offset:8192
    v_add_u32 v116, s49, v116
    v_and_b32 v116, 1, v116
    v_lshlrev_b32 v116, 6, v116
    v_mfma_f32_32x32x16_bf16 v[192:207], a[212:215], v[228:231], v[192:207]
    v_lshlrev_b32 v117, 4, v0
    v_xor_b32 v116, v116, v117
    v_mov_b32 v117, 1073741824
    v_cmp_gt_u32 vcc, 176, v0
    v_add_u32 v118, 150016, v127
    s_add_u32 m0, s82, 50176
    s_waitcnt lgkmcnt(3)
    v_mfma_f32_32x32x16_bf16 v[160:175], a[208:211], v[232:235], v[160:175]
    s_add_u32 s83, s55, 40960
    buffer_load_dwordx4 v8, s[32:35], s83 offen lds
    s_mul_i32 s52, s48, 88064
    v_cndmask_b32 v117, v117, v116, vcc
    s_mul_i32 s53, s49, 11008
    v_mfma_f32_32x32x16_bf16 v[208:223], a[212:215], v[232:235], v[208:223]
    s_add_u32 s52, s52, s53
    s_add_u32 s52, s52, 10485760
    s_add_u32 s53, s52, 4096
    s_add_u32 m0, s82, 51200
    s_add_u32 s83, s55, 49152
    buffer_load_dwordx4 v8, s[32:35], s83 offen lds
    s_add_u32 s54, s52, 8192
    v_bfe_u32 v15, v0, 2, 2
    s_waitcnt lgkmcnt(2)
    v_mfma_f32_32x32x16_bf16 v[128:143], a[216:219], v[236:239], v[128:143]
    s_waitcnt vmcnt(8)
    ds_read_b128 v[224:227], v11 offset:0
    v_lshl_add_u32 v2, v7, 3, v15
    v_lshlrev_b32 v2, 7, v2
    v_lshrrev_b32 v15, 1, v15
    v_mfma_f32_32x32x16_bf16 v[176:191], a[220:223], v[236:239], v[176:191]
    ds_read_b128 v[228:231], v12 offset:0
    v_xor_b32 v16, s72, v15
    v_lshl_add_u32 v16, v16, 6, v2
    s_add_u32 m0, s82, 52224
    s_add_u32 s83, s55, 57344
    s_waitcnt lgkmcnt(3)
    v_mfma_f32_32x32x16_bf16 v[144:159], a[216:219], v[240:243], v[144:159]
    ds_read_b128 v[232:235], v13 offset:0
    buffer_load_dwordx4 v8, s[32:35], s83 offen lds
    v_mfma_f32_32x32x16_bf16 v[192:207], a[220:223], v[240:243], v[192:207]
    v_bfe_u32 v17, v0, 4, 1
    v_lshl_add_u32 v16, v17, 5, v16
    v_and_b32 v7, 3, v0
    v_lshl_add_u32 v7, v7, 3, v16
    v_xor_b32 v16, s73, v15
    s_waitcnt lgkmcnt(3)
    v_mfma_f32_32x32x16_bf16 v[160:175], a[216:219], v[244:247], v[160:175]
    v_lshl_add_u32 v16, v16, 6, v2
    v_lshl_add_u32 v16, v17, 4, v16
    s_add_u32 m0, s82, 53248
    s_add_u32 s83, s55, 65536
    v_mfma_f32_32x32x16_bf16 v[208:223], a[220:223], v[244:247], v[208:223]
    buffer_load_dwordx4 v8, s[32:35], s83 offen lds
    v_and_b32 v17, 1, v0
    v_lshl_add_u32 v16, v17, 5, v16
    v_bfe_u32 v17, v0, 1, 1
    v_lshl_add_u32 v17, v17, 3, v16
    v_add_u32 v16, 45056, v17
    s_mov_b32 s64, 0x3f80
    s_mov_b32 s65, 0x3f800000
    s_waitcnt lgkmcnt(2)
    v_mfma_f32_32x32x16_bf16 v[128:143], a[224:227], v[224:227], v[128:143]
    s_waitcnt vmcnt(9)
    v_cmp_ne_u32 vcc, s51, v18
    ds_read_b128 v[236:239], v14 offset:0
    v_mfma_f32_32x32x16_bf16 v[176:191], a[228:231], v[224:227], v[176:191]
    v_cmp_ne_u32 s[100:101], s51, v19
    s_nop 0
    s_or_b64 vcc, vcc, s[100:101]
    s_waitcnt lgkmcnt(2)
    v_mfma_f32_32x32x16_bf16 v[128:143], a[232:235], v[228:231], v[128:143]
    s_cbranch_scc0 L_ok3
    s_mov_b32 s78, 0x200000
L_poll3:
    s_sleep 1
    buffer_load_dwordx2 v[18:19], v10, s[40:43], s80 offen sc1
    s_sub_u32 s78, s78, 1
    s_cbranch_scc1 L_end
    s_waitcnt vmcnt(0)
    v_cmp_ne_u32 vcc, s51, v18
    v_cmp_ne_u32 s[100:101], s51, v19
    s_nop 0
    s_or_b64 vcc, vcc, s[100:101]
    s_cbranch_scc1 L_poll3
L_ok3:
    ds_read_b128 v[240:243], v11 offset:4096
    v_mfma_f32_32x32x16_bf16 v[176:191], a[236:239], v[228:231], v[176:191]
    buffer_load_dword v119, v126, s[40:43], s68 offen
    s_waitcnt lgkmcnt(2)
    v_mfma_f32_32x32x16_bf16 v[128:143], a[240:243], v[232:235], v[128:143]
    ds_read_b64 v[92:93], v6 offset:0
    ds_read_b128 v[244:247], v12 offset:4096
    v_mfma_f32_32x32x16_bf16 v[176:191], a[244:247], v[232:235], v[176:191]
    ds_read_b64 v[94:95], v6 offset:4608
    ds_read_b64 v[96:97], v6 offset:9216
    s_waitcnt lgkmcnt(5)
    v_mfma_f32_32x32x16_bf16 v[128:143], a[248:251], v[236:239], v[128:143]
    ds_read_b64 v[98:99], v6 offset:64
    ds_read_b64 v[100:101], v6 offset:4672
    ds_read_b128 v[224:227], v13 offset:4096
    v_mfma_f32_32x32x16_bf16 v[176:191], a[252:255], v[236:239], v[176:191]
    ds_read_b64 v[102:103], v6 offset:9280
    s_waitcnt lgkmcnt(8)
    v_mfma_f32_32x32x16_bf16 v[144:159], a[224:227], v[240:243], v[144:159]
    ds_read_b128 v[228:231], v14 offset:4096
    v_mfma_f32_32x32x16_bf16 v[192:207], a[228:231], v[240:243], v[192:207]
    s_nop 2
    v_cvt_pk_bf16_f32 v132, v132, v133
    v_cvt_pk_bf16_f32 v133, v134, v135
    s_nop 1
    v_cvt_pk_bf16_f32 v134, v180, v181
    v_cvt_pk_bf16_f32 v135, v182, v183
    s_waitcnt lgkmcnt(7)
    v_mfma_f32_32x32x16_bf16 v[144:159], a[232:235], v[244:247], v[144:159]
    ds_write_b128 v1, v[132:135] offset:0
    v_cvt_pk_bf16_f32 v136, v136, v137
    v_cvt_pk_bf16_f32 v137, v138, v139
    v_cvt_pk_bf16_f32 v138, v184, v185
    v_cvt_pk_bf16_f32 v139, v186, v187
    ds_read_b128 v[232:235], v11 offset:8192
    v_mfma_f32_32x32x16_bf16 v[192:207], a[236:239], v[244:247], v[192:207]
    ds_write_b128 v1, v[136:139] offset:3072
    v_cvt_pk_bf16_f32 v140, v140, v141
    v_cvt_pk_bf16_f32 v141, v142, v143
    v_cvt_pk_bf16_f32 v142, v188, v189
    s_add_u32 m0, s82, 54272
    s_add_u32 s83, s55, 73728
    s_waitcnt lgkmcnt(5)
    v_mfma_f32_32x32x16_bf16 v[144:159], a[240:243], v[224:227], v[144:159]
    buffer_load_dwordx4 v8, s[32:35], s83 offen lds
    v_cvt_pk_bf16_f32 v143, v190, v191
    ds_write_b128 v1, v[140:143] offset:6144
    v_add_f32 v128, v128, v108
    v_add_f32 v129, v129, v109
    v_add_f32 v130, v130, v110
    ds_read_b128 v[236:239], v12 offset:8192
    v_mfma_f32_32x32x16_bf16 v[192:207], a[244:247], v[224:227], v[192:207]
    v_add_f32 v131, v131, v111
    v_lshlrev_b32 v180, 16, v92
    v_and_b32 v181, 0xffff0000, v92
    v_lshlrev_b32 v182, 16, v93
    s_waitcnt lgkmcnt(5)
    v_mfma_f32_32x32x16_bf16 v[144:159], a[248:251], v[228:231], v[144:159]
    v_and_b32 v183, 0xffff0000, v93
    v_add_f32 v176, v176, v112
    v_add_f32 v177, v177, v113
    v_add_f32 v178, v178, v114
    v_add_f32 v179, v179, v115
    ds_read_b128 v[240:243], v13 offset:8192
    v_mfma_f32_32x32x16_bf16 v[192:207], a[252:255], v[228:231], v[192:207]
    v_lshlrev_b32 v184, 16, v98
    v_and_b32 v185, 0xffff0000, v98
    v_lshlrev_b32 v186, 16, v99
    v_and_b32 v187, 0xffff0000, v99
    s_waitcnt lgkmcnt(4)
    v_mfma_f32_32x32x16_bf16 v[160:175], a[224:227], v[232:235], v[160:175]
    ds_read_b128 v[244:247], v14 offset:8192
    v_mfma_f32_32x32x16_bf16 v[208:223], a[228:231], v[232:235], v[208:223]
    v_cvt_pk_bf16_f32 v148, v148, v149
    v_cvt_pk_bf16_f32 v149, v150, v151
    s_nop 1
    v_cvt_pk_bf16_f32 v150, v196, v197
    v_cvt_pk_bf16_f32 v151, v198, v199
    s_waitcnt lgkmcnt(2)
    v_mfma_f32_32x32x16_bf16 v[160:175], a[232:235], v[236:239], v[160:175]
    ds_write_b128 v1, v[148:151] offset:1024
    v_cvt_pk_bf16_f32 v152, v152, v153
    v_cvt_pk_bf16_f32 v153, v154, v155
    v_cvt_pk_bf16_f32 v154, v200, v201
    v_cvt_pk_bf16_f32 v155, v202, v203
    v_mfma_f32_32x32x16_bf16 v[208:223], a[236:239], v[236:239], v[208:223]
    ds_write_b128 v1, v[152:155] offset:4096
    v_cvt_pk_bf16_f32 v156, v156, v157
    v_cvt_pk_bf16_f32 v157, v158, v159
    v_cvt_pk_bf16_f32 v158, v204, v205
    s_add_u32 m0, s82, 55296
    s_add_u32 s83, s55, 81920
    s_waitcnt lgkmcnt(3)
    v_mfma_f32_32x32x16_bf16 v[160:175], a[240:243], v[240:243], v[160:175]
    buffer_load_dwordx4 v8, s[32:35], s83 offen lds
    v_cvt_pk_bf16_f32 v159, v206, v207
    ds_write_b128 v1, v[156:159] offset:7168
    v_add_f32 v144, v144, v108
    v_add_f32 v145, v145, v109
    v_add_f32 v146, v146, v110
    v_mfma_f32_32x32x16_bf16 v[208:223], a[244:247], v[240:243], v[208:223]
    v_add_f32 v147, v147, v111
    v_lshlrev_b32 v196, 16, v94
    v_and_b32 v197, 0xffff0000, v94
    v_lshlrev_b32 v198, 16, v95
    s_waitcnt lgkmcnt(3)
    v_mfma_f32_32x32x16_bf16 v[160:175], a[248:251], v[244:247], v[160:175]
    v_and_b32 v199, 0xffff0000, v95
    v_add_f32 v192, v192, v112
    v_add_f32 v193, v193, v113
    v_add_f32 v194, v194, v114
    v_add_f32 v195, v195, v115
    v_mfma_f32_32x32x16_bf16 v[208:223], a[252:255], v[244:247], v[208:223]
    v_lshlrev_b32 v200, 16, v100
    v_and_b32 v201, 0xffff0000, v100
    v_lshlrev_b32 v202, 16, v101
    v_and_b32 v203, 0xffff0000, v101
    s_nop 1
    v_cvt_pk_bf16_f32 v164, v164, v165
    v_cvt_pk_bf16_f32 v165, v166, v167
    s_nop 3
    v_cvt_pk_bf16_f32 v166, v212, v213
    v_cvt_pk_bf16_f32 v167, v214, v215
    ds_write_b128 v1, v[164:167] offset:2048
    v_cvt_pk_bf16_f32 v168, v168, v169
    v_cvt_pk_bf16_f32 v169, v170, v171
    v_cvt_pk_bf16_f32 v170, v216, v217
    v_cvt_pk_bf16_f32 v171, v218, v219
    ds_write_b128 v1, v[168:171] offset:5120
    v_cvt_pk_bf16_f32 v172, v172, v173
    v_cvt_pk_bf16_f32 v173, v174, v175
    v_cvt_pk_bf16_f32 v174, v220, v221
    v_cvt_pk_bf16_f32 v175, v222, v223
    ds_write_b128 v1, v[172:175] offset:8192
    v_add_f32 v160, v160, v108
    v_add_f32 v161, v161, v109
    v_add_f32 v162, v162, v110
    v_add_f32 v163, v163, v111
    v_lshlrev_b32 v224, 16, v96
    v_and_b32 v225, 0xffff0000, v96
    v_lshlrev_b32 v226, 16, v97
    v_and_b32 v227, 0xffff0000, v97
    v_add_f32 v208, v208, v112
    v_add_f32 v209, v209, v113
    v_add_f32 v210, v210, v114
    v_add_f32 v211, v211, v115
    v_lshlrev_b32 v228, 16, v102
    v_and_b32 v229, 0xffff0000, v102
    v_lshlrev_b32 v230, 16, v103
    v_and_b32 v231, 0xffff0000, v103
    s_waitcnt lgkmcnt(0)
    s_barrier
    s_add_u32 m0, s76, 0
    s_add_u32 s83, s75, 360448
    buffer_load_dwordx4 v8, s[32:35], s83 offen lds
    ds_read_b128 v[132:135], v3 offset:0
    ds_read_b128 v[136:139], v4 offset:3072
    ds_read_b128 v[140:143], v5 offset:6144
    ds_read_b128 v[148:151], v3 offset:1024
    ds_read_b128 v[152:155], v4 offset:4096
    ds_read_b128 v[156:159], v5 offset:7168
    ds_read_b128 v[164:167], v3 offset:2048
    ds_read_b128 v[168:171], v4 offset:5120
    ds_read_b128 v[172:175], v5 offset:8192
    s_waitcnt lgkmcnt(8)
    v_dot2_f32_bf16 v128, v132, s64, v128
    s_add_u32 m0, s76, 4096
    s_add_u32 s83, s75, 393216
    buffer_load_dwordx4 v8, s[32:35], s83 offen lds
    v_dot2_f32_bf16 v129, v132, s65, v129
    v_dot2_f32_bf16 v130, v133, s64, v130
    v_dot2_f32_bf16 v131, v133, s65, v131
    v_dot2_f32_bf16 v176, v134, s64, v176
    v_dot2_f32_bf16 v177, v134, s65, v177
    v_dot2_f32_bf16 v178, v135, s64, v178
    v_dot2_f32_bf16 v179, v135, s65, v179
    s_waitcnt lgkmcnt(7)
    v_dot2_f32_bf16 v128, v136, s64, v128
    v_dot2_f32_bf16 v129, v136, s65, v129
    s_add_u32 m0, s76, 8192
    s_add_u32 s83, s75, 425984
    buffer_load_dwordx4 v8, s[32:35], s83 offen lds
    v_dot2_f32_bf16 v130, v137, s64, v130
    v_dot2_f32_bf16 v131, v137, s65, v131
    v_dot2_f32_bf16 v176, v138, s64, v176
    v_dot2_f32_bf16 v177, v138, s65, v177
    v_dot2_f32_bf16 v178, v139, s64, v178
    v_dot2_f32_bf16 v179, v139, s65, v179
    s_waitcnt lgkmcnt(6)
    v_dot2_f32_bf16 v128, v140, s64, v128
    v_dot2_f32_bf16 v129, v140, s65, v129
    v_dot2_f32_bf16 v130, v141, s64, v130
    s_add_u32 m0, s76, 12288
    s_add_u32 s83, s75, 458752
    buffer_load_dwordx4 v8, s[32:35], s83 offen lds
    v_dot2_f32_bf16 v131, v141, s65, v131
    v_dot2_f32_bf16 v176, v142, s64, v176
    v_dot2_f32_bf16 v177, v142, s65, v177
    v_dot2_f32_bf16 v178, v143, s64, v178
    v_dot2_f32_bf16 v179, v143, s65, v179
    v_pk_mul_f32 v[128:129], v[128:129], v[180:181]
    v_pk_mul_f32 v[130:131], v[130:131], v[182:183]
    v_cvt_pk_bf16_f32 v180, v128, v129
    v_cvt_pk_bf16_f32 v181, v130, v131
    s_add_u32 m0, s76, 16384
    s_add_u32 s83, s75, 491520
    buffer_load_dwordx4 v8, s[32:35], s83 offen lds
    ds_write_b64 v6, v[180:181] offset:0
    v_pk_mul_f32 v[176:177], v[176:177], v[184:185]
    v_pk_mul_f32 v[178:179], v[178:179], v[186:187]
    v_cvt_pk_bf16_f32 v184, v176, v177
    v_cvt_pk_bf16_f32 v185, v178, v179
    ds_write_b64 v6, v[184:185] offset:64
    s_waitcnt lgkmcnt(7)
    v_dot2_f32_bf16 v144, v148, s64, v144
    v_dot2_f32_bf16 v145, v148, s65, v145
    v_dot2_f32_bf16 v146, v149, s64, v146
    s_add_u32 m0, s76, 20480
    s_add_u32 s83, s75, 524288
    buffer_load_dwordx4 v8, s[32:35], s83 offen lds
    v_dot2_f32_bf16 v147, v149, s65, v147
    v_dot2_f32_bf16 v192, v150, s64, v192
    v_dot2_f32_bf16 v193, v150, s65, v193
    v_dot2_f32_bf16 v194, v151, s64, v194
    v_dot2_f32_bf16 v195, v151, s65, v195
    s_waitcnt lgkmcnt(6)
    v_dot2_f32_bf16 v144, v152, s64, v144
    v_dot2_f32_bf16 v145, v152, s65, v145
    v_dot2_f32_bf16 v146, v153, s64, v146
    v_dot2_f32_bf16 v147, v153, s65, v147
    s_add_u32 m0, s76, 24576
    s_add_u32 s83, s75, 557056
    buffer_load_dwordx4 v8, s[32:35], s83 offen lds
    v_dot2_f32_bf16 v192, v154, s64, v192
    v_dot2_f32_bf16 v193, v154, s65, v193
    v_dot2_f32_bf16 v194, v155, s64, v194
    v_dot2_f32_bf16 v195, v155, s65, v195
    s_waitcnt lgkmcnt(5)
    v_dot2_f32_bf16 v144, v156, s64, v144
    v_dot2_f32_bf16 v145, v156, s65, v145
    v_dot2_f32_bf16 v146, v157, s64, v146
    v_dot2_f32_bf16 v147, v157, s65, v147
    v_dot2_f32_bf16 v192, v158, s64, v192
    s_add_u32 m0, s76, 28672
    s_add_u32 s83, s75, 589824
    buffer_load_dwordx4 v8, s[32:35], s83 offen lds
    v_dot2_f32_bf16 v193, v158, s65, v193
    v_dot2_f32_bf16 v194, v159, s64, v194
    v_dot2_f32_bf16 v195, v159, s65, v195
    v_pk_mul_f32 v[144:145], v[144:145], v[196:197]
    v_pk_mul_f32 v[146:147], v[146:147], v[198:199]
    v_cvt_pk_bf16_f32 v196, v144, v145
    v_cvt_pk_bf16_f32 v197, v146, v147
    ds_write_b64 v6, v[196:197] offset:4608
    v_pk_mul_f32 v[192:193], v[192:193], v[200:201]
    s_add_u32 m0, s76, 32768
    s_add_u32 s83, s75, 622592
    buffer_load_dwordx4 v8, s[32:35], s83 offen lds
    v_pk_mul_f32 v[194:195], v[194:195], v[202:203]
    v_cvt_pk_bf16_f32 v200, v192, v193
    v_cvt_pk_bf16_f32 v201, v194, v195
    ds_write_b64 v6, v[200:201] offset:4672
    s_waitcnt lgkmcnt(6)
    v_dot2_f32_bf16 v160, v164, s64, v160
    v_dot2_f32_bf16 v161, v164, s65, v161
    v_dot2_f32_bf16 v162, v165, s64, v162
    v_dot2_f32_bf16 v163, v165, s65, v163
    v_dot2_f32_bf16 v208, v166, s64, v208
    s_add_u32 m0, s76, 36864
    s_add_u32 s83, s75, 655360
    buffer_load_dwordx4 v8, s[32:35], s83 offen lds
    v_dot2_f32_bf16 v209, v166, s65, v209
    v_dot2_f32_bf16 v210, v167, s64, v210
    v_dot2_f32_bf16 v211, v167, s65, v211
    s_waitcnt lgkmcnt(5)
    v_dot2_f32_bf16 v160, v168, s64, v160
    v_dot2_f32_bf16 v161, v168, s65, v161
    v_dot2_f32_bf16 v162, v169, s64, v162
    v_dot2_f32_bf16 v163, v169, s65, v163
    v_dot2_f32_bf16 v208, v170, s64, v208
    v_dot2_f32_bf16 v209, v170, s65, v209
    s_add_u32 m0, s76, 40960
    s_add_u32 s83, s75, 688128
    buffer_load_dwordx4 v8, s[32:35], s83 offen lds
    v_dot2_f32_bf16 v210, v171, s64, v210
    v_dot2_f32_bf16 v211, v171, s65, v211
    s_waitcnt lgkmcnt(4)
    v_dot2_f32_bf16 v160, v172, s64, v160
    v_dot2_f32_bf16 v161, v172, s65, v161
    v_dot2_f32_bf16 v162, v173, s64, v162
    v_dot2_f32_bf16 v163, v173, s65, v163
    v_dot2_f32_bf16 v208, v174, s64, v208
    v_dot2_f32_bf16 v209, v174, s65, v209
    v_dot2_f32_bf16 v210, v175, s64, v210
    v_dot2_f32_bf16 v211, v175, s65, v211
    v_pk_mul_f32 v[160:161], v[160:161], v[224:225]
    v_pk_mul_f32 v[162:163], v[162:163], v[226:227]
    v_cvt_pk_bf16_f32 v224, v160, v161
    v_cvt_pk_bf16_f32 v225, v162, v163
    ds_write_b64 v6, v[224:225] offset:9216
    v_pk_mul_f32 v[208:209], v[208:209], v[228:229]
    v_pk_mul_f32 v[210:211], v[210:211], v[230:231]
    v_cvt_pk_bf16_f32 v228, v208, v209
    v_cvt_pk_bf16_f32 v229, v210, v211
    ds_write_b64 v6, v[228:229] offset:9280
    s_waitcnt lgkmcnt(0)
    s_barrier
    ds_read_b128 v[128:131], v118 offset:0
    ds_read_b128 v[132:135], v118 offset:4608
    ds_read_b128 v[136:139], v118 offset:9216
    s_waitcnt lgkmcnt(2)
    buffer_store_dwordx4 v[128:131], v116, s[40:43], s52 offen sc1
    s_waitcnt lgkmcnt(1)
    buffer_store_dwordx4 v[132:135], v116, s[40:43], s53 offen sc1
    s_waitcnt lgkmcnt(0)
    buffer_store_dwordx4 v[136:139], v117, s[40:43], s54 offen sc1
    s_waitcnt vmcnt(3)
    s_barrier
    s_add_u32 m0, s76, 90112
    s_add_u32 s83, s77, 0
    buffer_load_dwordx4 v10, s[40:43], s83 offen lds
    ds_read_b64_tr_b16 a[0:1], v16 offset:0
    v_mov_b32 v4, s51
    ds_read_b64_tr_b16 a[2:3], v16 offset:512
    v_mov_b32 v5, s51
    ds_read_b64_tr_b16 a[4:5], v16 offset:2048
    v_cmp_eq_u32 vcc, 0, v0
    ds_read_b64_tr_b16 a[6:7], v16 offset:2560
    v_mov_b32 v6, 1073741824
    s_add_u32 m0, s76, 94208
    s_add_u32 s83, s77, 4096
    buffer_load_dwordx4 v10, s[40:43], s83 offen lds
    ds_read_b64_tr_b16 a[8:9], v16 offset:4096
    s_lshl_b32 s52, s48, 3
    ds_read_b64_tr_b16 a[10:11], v16 offset:4608
    s_add_u32 s52, s52, s49
    ds_read_b64_tr_b16 a[12:13], v16 offset:6144
    v_cndmask_b32 v6, v6, 0, vcc
    ds_read_b64_tr_b16 a[14:15], v16 offset:6656
    s_add_u32 m0, s76, 98304
    s_add_u32 s83, s77, 8192
    buffer_load_dwordx4 v10, s[40:43], s83 offen lds
    s_lshl_b32 s52, s52, 4
    ds_read_b64_tr_b16 a[16:17], v16 offset:8192
    s_add_u32 s52, s52, 458752
    ds_read_b64_tr_b16 a[18:19], v16 offset:8704
    v_mov_b32 v1, 1073741824
    ds_read_b64_tr_b16 a[20:21], v16 offset:10240
    v_or_b32 v2, s2, v0
    ds_read_b64_tr_b16 a[22:23], v16 offset:10752
    s_add_u32 m0, s76, 102400
    s_add_u32 s83, s77, 12288
    buffer_load_dwordx4 v10, s[40:43], s83 offen lds
    v_cmp_eq_u32 vcc, 0, v2
    ds_read_b64_tr_b16 a[24:25], v16 offset:12288
    s_nop 0
    ds_read_b64_tr_b16 a[26:27], v16 offset:12800
    s_nop 0
    ds_read_b64_tr_b16 a[28:29], v16 offset:14336
    v_cndmask_b32 v2, v1, 0, vcc
    s_add_u32 m0, s76, 106496
    s_add_u32 s83, s77, 16384
    buffer_load_dwordx4 v10, s[40:43], s83 offen lds
    ds_read_b64_tr_b16 a[30:31], v16 offset:14848
    ds_read_b64_tr_b16 a[32:33], v16 offset:16384
    ds_read_b64_tr_b16 a[34:35], v16 offset:16896
    ds_read_b64_tr_b16 a[36:37], v16 offset:18432
    ds_read_b64_tr_b16 a[38:39], v16 offset:18944
    ds_read_b64_tr_b16 a[40:41], v16 offset:20480
    ds_read_b64_tr_b16 a[42:43], v16 offset:20992
    s_add_u32 m0, s76, 110592
    s_add_u32 s83, s77, 20480
    buffer_load_dwordx4 v10, s[40:43], s83 offen lds
    ds_read_b64_tr_b16 a[44:45], v16 offset:22528
    ds_read_b64_tr_b16 a[46:47], v16 offset:23040
    ds_read_b64_tr_b16 a[48:49], v16 offset:24576
    ds_read_b64_tr_b16 a[50:51], v16 offset:25088
    ds_read_b64_tr_b16 a[52:53], v16 offset:26624
    ds_read_b64_tr_b16 a[54:55], v16 offset:27136
    ds_read_b64_tr_b16 a[56:57], v16 offset:28672
    ds_read_b64_tr_b16 a[58:59], v16 offset:29184
    s_add_u32 m0, s76, 114688
    s_add_u32 s83, s77, 24576
    buffer_load_dwordx4 v10, s[40:43], s83 offen lds
    ds_read_b64_tr_b16 a[60:61], v16 offset:30720
    ds_read_b64_tr_b16 a[62:63], v16 offset:31232
    ds_read_b64_tr_b16 a[64:65], v16 offset:32768
    ds_read_b64_tr_b16 a[66:67], v16 offset:33280
    ds_read_b64_tr_b16 a[68:69], v16 offset:34816
    ds_read_b64_tr_b16 a[70:71], v16 offset:35328
    ds_read_b64_tr_b16 a[72:73], v16 offset:36864
    s_add_u32 m0, s76, 118784
    s_add_u32 s83, s77, 28672
    buffer_load_dwordx4 v10, s[40:43], s83 offen lds
    ds_read_b64_tr_b16 a[74:75], v16 offset:37376
    ds_read_b64_tr_b16 a[76:77], v16 offset:38912
    ds_read_b64_tr_b16 a[78:79], v16 offset:39424
    ds_read_b64_tr_b16 a[80:81], v16 offset:40960
    ds_read_b64_tr_b16 a[82:83], v16 offset:41472
    ds_read_b64_tr_b16 a[84:85], v16 offset:43008
    ds_read_b64_tr_b16 a[86:87], v16 offset:43520
    s_waitcnt vmcnt(8)
    s_barrier
    buffer_store_dwordx2 v[4:5], v6, s[40:43], s52 offen sc1
    buffer_store_dword v4, v2, s[40:43], 0 offen sc1
    s_add_u32 m0, s76, 122880
    s_add_u32 s83, s77, 32768
    buffer_load_dwordx4 v10, s[40:43], s83 offen lds
    ds_read_b64_tr_b16 a[88:89], v17 offset:0
    v_add_u32 v11, 45056, v7
    ds_read_b64_tr_b16 a[90:91], v17 offset:512
    v_add_u32 v13, 90112, v7
    ds_read_b64_tr_b16 a[92:93], v17 offset:2048
    v_mov_b32 v1, 0x3f00
    ds_read_b64_tr_b16 a[94:95], v17 offset:2560
    v_cndmask_b32 v88, v24, v1, s[62:63]
    ds_read_b64_tr_b16 a[96:97], v17 offset:4096
    v_mov_b32 v89, v25
    s_add_u32 m0, s76, 126976
    s_add_u32 s83, s77, 36864
    buffer_load_dwordx4 v10, s[40:43], s83 offen lds
    ds_read_b64_tr_b16 a[98:99], v17 offset:4608
    v_mov_b32 v90, v26
    ds_read_b64_tr_b16 a[100:101], v17 offset:6144
    v_mov_b32 v91, v27
    ds_read_b64_tr_b16 a[102:103], v17 offset:6656
    v_and_b32 v15, 7, v0
    ds_read_b64_tr_b16 a[104:105], v17 offset:8192
    v_lshlrev_b32 v15, 4, v15
    ds_read_b64_tr_b16 a[106:107], v17 offset:8704
    s_add_u32 m0, s76, 131072
    s_add_u32 s83, s77, 40960
    buffer_load_dwordx4 v10, s[40:43], s83 offen lds
    s_lshl_b32 s80, s70, 7
    ds_read_b64_tr_b16 a[108:109], v17 offset:10240
    s_add_u32 s80, s80, 458752
    ds_read_b64_tr_b16 a[110:111], v17 offset:10752
    s_mul_i32 s79, s70, 88064
    ds_read_b64_tr_b16 a[112:113], v17 offset:12288
    s_add_u32 s79, s79, s76
    ds_read_b64_tr_b16 a[114:115], v17 offset:12800
    s_add_u32 s79, s79, 10485760
    s_add_u32 m0, s76, 135168
    s_add_u32 s83, s77, 45056
    buffer_load_dwordx4 v10, s[40:43], s83 offen lds
    ds_read_b64_tr_b16 a[116:117], v17 offset:14336
    v_mov_b32 v1, 1073741824
    ds_read_b64_tr_b16 a[118:119], v17 offset:14848
    v_mov_b32 v14, s50
    ds_read_b64_tr_b16 a[120:121], v17 offset:16384
    v_cmp_gt_u32 vcc, 2, v14
    ds_read_b64_tr_b16 a[122:123], v17 offset:16896
    s_nop 0
    v_cndmask_b32 v14, v1, v10, vcc
    ds_read_b64_tr_b16 a[124:125], v17 offset:18432
    s_add_u32 m0, s76, 139264
    s_add_u32 s83, s77, 49152
    buffer_load_dwordx4 v10, s[40:43], s83 offen lds
    s_lshl_b32 s53, s50, 11
    ds_read_b64_tr_b16 a[126:127], v17 offset:18944
    s_add_u32 s53, s53, 155648
    ds_read_b64_tr_b16 a[128:129], v17 offset:20480
    s_add_u32 s54, s74, 16384
    ds_read_b64_tr_b16 a[130:131], v17 offset:20992
    v_bfe_u32 v3, v0, 5, 1
    ds_read_b64_tr_b16 a[132:133], v17 offset:22528
    v_lshlrev_b32 v3, 1, v3
    s_add_u32 m0, s76, 143360
    s_add_u32 s83, s77, 53248
    buffer_load_dwordx4 v10, s[40:43], s83 offen lds
    ds_read_b64_tr_b16 a[134:135], v17 offset:23040
    v_bfe_u32 v12, v0, 2, 2
    ds_read_b64_tr_b16 a[136:137], v17 offset:24576
    v_xor_b32 v3, v3, v12
    ds_read_b64_tr_b16 a[138:139], v17 offset:25088
    v_lshlrev_b32 v3, 4, v3
    ds_read_b64_tr_b16 a[140:141], v17 offset:26624
    v_and_b32 v12, 31, v0
    ds_read_b64_tr_b16 a[142:143], v17 offset:27136
    s_add_u32 m0, s76, 147456
    s_add_u32 s83, s77, 57344
    buffer_load_dwordx4 v10, s[40:43], s83 offen lds
    v_lshl_add_u32 v12, v12, 6, v3
    ds_read_b64_tr_b16 a[144:145], v17 offset:28672
    v_add_u32 v12, s53, v12
    ds_read_b64_tr_b16 a[146:147], v17 offset:29184
    v_xor_b32 v3, 16, v12
    ds_read_b64_tr_b16 a[148:149], v17 offset:30720
    v_add_u32 v8, s53, v10
    ds_read_b64_tr_b16 a[150:151], v17 offset:31232
    ds_read_b64_tr_b16 a[152:153], v17 offset:32768
    s_add_u32 m0, s76, 151552
    s_add_u32 s83, s77, 61440
    buffer_load_dwordx4 v10, s[40:43], s83 offen lds
    ds_read_b64_tr_b16 a[154:155], v17 offset:33280
    ds_read_b64_tr_b16 a[156:157], v17 offset:34816
    ds_read_b64_tr_b16 a[158:159], v17 offset:35328
    ds_read_b64_tr_b16 a[160:161], v17 offset:36864
    ds_read_b64_tr_b16 a[162:163], v17 offset:37376
    ds_read_b64_tr_b16 a[164:165], v17 offset:38912
    ds_read_b64_tr_b16 a[166:167], v17 offset:39424
    ds_read_b64_tr_b16 a[168:169], v17 offset:40960
    ds_read_b64_tr_b16 a[170:171], v17 offset:41472
    s_add_u32 m0, s53, 0
    s_nop 0
    buffer_load_dwordx4 v9, s[8:11], s74 offen lds
    s_add_u32 m0, s53, 1024
    s_nop 0
    buffer_load_dwordx4 v9, s[8:11], s54 offen lds
    s_waitcnt vmcnt(2)
    s_waitcnt lgkmcnt(0)
    s_barrier
    ds_read_b64_tr_b16 v[192:193], v13 offset:0
    ds_read_b64_tr_b16 v[194:195], v13 offset:512
    ds_read_b64_tr_b16 v[196:197], v13 offset:2048
    ds_read_b64_tr_b16 v[198:199], v13 offset:2560
    ds_read_b64_tr_b16 v[200:201], v13 offset:4096
    ds_read_b64_tr_b16 v[202:203], v13 offset:4608
    ds_read_b64_tr_b16 v[204:205], v13 offset:6144
    ds_read_b64_tr_b16 v[206:207], v13 offset:6656
    ds_read_b64_tr_b16 v[208:209], v13 offset:8192
    ds_read_b64_tr_b16 v[210:211], v13 offset:8704
    s_waitcnt lgkmcnt(8)
    v_mfma_f32_32x32x16_bf16 v[144:159], v[24:27], v[192:195], 0
    ds_read_b64_tr_b16 v[212:213], v13 offset:10240
    ds_read_b64_tr_b16 v[214:215], v13 offset:10752
    s_waitcnt lgkmcnt(8)
    v_mfma_f32_32x32x16_bf16 v[144:159], v[28:31], v[196:199], v[144:159]
    ds_read_b64_tr_b16 v[192:193], v13 offset:12288
    ds_read_b64_tr_b16 v[194:195], v13 offset:12800
    s_waitcnt lgkmcnt(8)
    v_mfma_f32_32x32x16_bf16 v[144:159], v[32:35], v[200:203], v[144:159]
    ds_read_b64_tr_b16 v[196:197], v13 offset:14336
    ds_read_b64_tr_b16 v[198:199], v13 offset:14848
    s_waitcnt lgkmcnt(8)
    v_mfma_f32_32x32x16_bf16 v[144:159], v[36:39], v[204:207], v[144:159]
    ds_read_b64_tr_b16 v[200:201], v13 offset:16384
    ds_read_b64_tr_b16 v[202:203], v13 offset:16896
    s_waitcnt lgkmcnt(8)
    v_mfma_f32_32x32x16_bf16 v[144:159], v[40:43], v[208:211], v[144:159]
    ds_read_b64_tr_b16 v[204:205], v13 offset:18432
    ds_read_b64_tr_b16 v[206:207], v13 offset:18944
    s_waitcnt lgkmcnt(8)
    v_mfma_f32_32x32x16_bf16 v[144:159], v[44:47], v[212:215], v[144:159]
    ds_read_b64_tr_b16 v[208:209], v13 offset:20480
    ds_read_b64_tr_b16 v[210:211], v13 offset:20992
    s_waitcnt lgkmcnt(8)
    v_mfma_f32_32x32x16_bf16 v[144:159], v[48:51], v[192:195], v[144:159]
    ds_read_b64_tr_b16 v[212:213], v13 offset:22528
    ds_read_b64_tr_b16 v[214:215], v13 offset:23040
    s_waitcnt lgkmcnt(8)
    v_mfma_f32_32x32x16_bf16 v[144:159], v[52:55], v[196:199], v[144:159]
    ds_read_b64_tr_b16 v[192:193], v13 offset:24576
    ds_read_b64_tr_b16 v[194:195], v13 offset:25088
    s_waitcnt lgkmcnt(8)
    v_mfma_f32_32x32x16_bf16 v[144:159], v[56:59], v[200:203], v[144:159]
    buffer_load_dwordx2 v[18:19], v15, s[40:43], s80 offen sc1
    ds_read_b64_tr_b16 v[196:197], v13 offset:26624
    ds_read_b64_tr_b16 v[198:199], v13 offset:27136
    s_waitcnt lgkmcnt(8)
    v_mfma_f32_32x32x16_bf16 v[144:159], v[60:63], v[204:207], v[144:159]
    ds_read_b64_tr_b16 v[200:201], v13 offset:28672
    ds_read_b64_tr_b16 v[202:203], v13 offset:29184
    s_waitcnt lgkmcnt(8)
    v_mfma_f32_32x32x16_bf16 v[144:159], v[64:67], v[208:211], v[144:159]
    ds_read_b64_tr_b16 v[204:205], v13 offset:30720
    ds_read_b64_tr_b16 v[206:207], v13 offset:31232
    s_waitcnt lgkmcnt(8)
    v_mfma_f32_32x32x16_bf16 v[144:159], v[68:71], v[212:215], v[144:159]
    ds_read_b64_tr_b16 v[208:209], v13 offset:32768
    ds_read_b64_tr_b16 v[210:211], v13 offset:33280
    s_waitcnt lgkmcnt(8)
    v_mfma_f32_32x32x16_bf16 v[144:159], v[72:75], v[192:195], v[144:159]
    ds_read_b64_tr_b16 v[212:213], v13 offset:34816
    ds_read_b64_tr_b16 v[214:215], v13 offset:35328
    s_waitcnt lgkmcnt(8)
    v_mfma_f32_32x32x16_bf16 v[144:159], v[76:79], v[196:199], v[144:159]
    ds_read_b64_tr_b16 v[192:193], v13 offset:36864
    ds_read_b64_tr_b16 v[194:195], v13 offset:37376
    s_waitcnt lgkmcnt(8)
    v_mfma_f32_32x32x16_bf16 v[144:159], v[80:83], v[200:203], v[144:159]
    ds_read_b64_tr_b16 v[196:197], v13 offset:38912
    ds_read_b64_tr_b16 v[198:199], v13 offset:39424
    s_waitcnt lgkmcnt(8)
    v_mfma_f32_32x32x16_bf16 v[144:159], v[84:87], v[204:207], v[144:159]
    ds_read_b64_tr_b16 v[200:201], v13 offset:40960
    ds_read_b64_tr_b16 v[202:203], v13 offset:41472
    s_waitcnt vmcnt(0)
    v_cmp_ne_u32 vcc, s51, v18
    v_cmp_ne_u32 s[100:101], s51, v19
    s_nop 0
    s_or_b64 vcc, vcc, s[100:101]
    s_cbranch_scc0 L_ok4
    s_mov_b32 s78, 0x200000
L_poll4:
    s_sleep 1
    buffer_load_dwordx2 v[18:19], v15, s[40:43], s80 offen sc1
    s_sub_u32 s78, s78, 1
    s_cbranch_scc1 L_end
    s_waitcnt vmcnt(0)
    v_cmp_ne_u32 vcc, s51, v18
    v_cmp_ne_u32 s[100:101], s51, v19
    s_nop 0
    s_or_b64 vcc, vcc, s[100:101]
    s_cbranch_scc1 L_poll4
L_ok4:
    s_add_u32 m0, s76, 45056
    s_add_u32 s83, s79, 0
    buffer_load_dwordx4 v10, s[40:43], s83 offen lds
    s_add_u32 m0, s76, 49152
    s_add_u32 s83, s79, 4096
    buffer_load_dwordx4 v10, s[40:43], s83 offen lds
    s_add_u32 m0, s76, 53248
    s_add_u32 s83, s79, 8192
    buffer_load_dwordx4 v10, s[40:43], s83 offen lds
    s_add_u32 m0, s76, 57344
    s_add_u32 s83, s79, 12288
    buffer_load_dwordx4 v10, s[40:43], s83 offen lds
    s_add_u32 m0, s76, 61440
    s_add_u32 s83, s79, 16384
    buffer_load_dwordx4 v10, s[40:43], s83 offen lds
    s_add_u32 m0, s76, 65536
    s_add_u32 s83, s79, 20480
    buffer_load_dwordx4 v10, s[40:43], s83 offen lds
    s_add_u32 m0, s76, 69632
    s_add_u32 s83, s79, 24576
    buffer_load_dwordx4 v10, s[40:43], s83 offen lds
    s_add_u32 m0, s76, 73728
    s_add_u32 s83, s79, 28672
    buffer_load_dwordx4 v10, s[40:43], s83 offen lds
    s_waitcnt lgkmcnt(8)
    v_mfma_f32_32x32x16_bf16 v[160:175], v[88:91], v[208:211], 0
    ds_read_b64_tr_b16 v[204:205], v13 offset:43008
    ds_read_b64_tr_b16 v[206:207], v13 offset:43520
    s_waitcnt lgkmcnt(8)
    v_mfma_f32_32x32x16_bf16 v[160:175], v[28:31], v[212:215], v[160:175]
    ds_read_b64_tr_b16 v[208:209], v13 offset:45056
    ds_read_b64_tr_b16 v[210:211], v13 offset:45568
    s_waitcnt lgkmcnt(8)
    v_mfma_f32_32x32x16_bf16 v[160:175], v[32:35], v[192:195], v[160:175]
    ds_read_b64_tr_b16 v[212:213], v13 offset:47104
    ds_read_b64_tr_b16 v[214:215], v13 offset:47616
    s_waitcnt lgkmcnt(8)
    v_mfma_f32_32x32x16_bf16 v[160:175], v[36:39], v[196:199], v[160:175]
    ds_read_b64_tr_b16 v[192:193], v13 offset:49152
    ds_read_b64_tr_b16 v[194:195], v13 offset:49664
    s_waitcnt lgkmcnt(8)
    v_mfma_f32_32x32x16_bf16 v[160:175], v[40:43], v[200:203], v[160:175]
    ds_read_b64_tr_b16 v[196:197], v13 offset:51200
    ds_read_b64_tr_b16 v[198:199], v13 offset:51712
    s_add_u32 m0, s76, 77824
    s_add_u32 s83, s79, 32768
    s_waitcnt lgkmcnt(8)
    v_mfma_f32_32x32x16_bf16 v[160:175], v[44:47], v[204:207], v[160:175]
    buffer_load_dwordx4 v10, s[40:43], s83 offen lds
    ds_read_b64_tr_b16 v[200:201], v13 offset:53248
    ds_read_b64_tr_b16 v[202:203], v13 offset:53760
    s_add_u32 m0, s76, 81920
    s_add_u32 s83, s79, 36864
    s_waitcnt lgkmcnt(8)
    v_mfma_f32_32x32x16_bf16 v[160:175], v[48:51], v[208:211], v[160:175]
    buffer_load_dwordx4 v10, s[40:43], s83 offen lds
    ds_read_b64_tr_b16 v[204:205], v13 offset:55296
    ds_read_b64_tr_b16 v[206:207], v13 offset:55808
    s_waitcnt lgkmcnt(8)
    v_mfma_f32_32x32x16_bf16 v[160:175], v[52:55], v[212:215], v[160:175]
    ds_read_b64_tr_b16 v[208:209], v13 offset:57344
    ds_read_b64_tr_b16 v[210:211], v13 offset:57856
    s_add_u32 m0, s76, 86016
    s_add_u32 s83, s79, 40960
    s_waitcnt lgkmcnt(8)
    v_mfma_f32_32x32x16_bf16 v[160:175], v[56:59], v[192:195], v[160:175]
    buffer_load_dwordx4 v10, s[40:43], s83 offen lds
    ds_read_b64_tr_b16 v[212:213], v13 offset:59392
    ds_read_b64_tr_b16 v[214:215], v13 offset:59904
    s_add_u32 m0, s76, 0
    s_add_u32 s83, s79, 45056
    s_waitcnt lgkmcnt(8)
    v_mfma_f32_32x32x16_bf16 v[160:175], v[60:63], v[196:199], v[160:175]
    buffer_load_dwordx4 v10, s[40:43], s83 offen lds
    ds_read_b64_tr_b16 v[192:193], v13 offset:61440
    ds_read_b64_tr_b16 v[194:195], v13 offset:61952
    s_waitcnt lgkmcnt(8)
    v_mfma_f32_32x32x16_bf16 v[160:175], v[64:67], v[200:203], v[160:175]
    ds_read_b64_tr_b16 v[196:197], v13 offset:63488
    ds_read_b64_tr_b16 v[198:199], v13 offset:64000
    s_add_u32 m0, s76, 4096
    s_add_u32 s83, s79, 49152
    s_waitcnt lgkmcnt(8)
    v_mfma_f32_32x32x16_bf16 v[160:175], v[68:71], v[204:207], v[160:175]
    buffer_load_dwordx4 v10, s[40:43], s83 offen lds
    s_add_u32 m0, s76, 8192
    s_add_u32 s83, s79, 53248
    s_waitcnt lgkmcnt(6)
    v_mfma_f32_32x32x16_bf16 v[160:175], v[72:75], v[208:211], v[160:175]
    buffer_load_dwordx4 v10, s[40:43], s83 offen lds
    s_add_u32 m0, s76, 12288
    s_add_u32 s83, s79, 57344
    s_waitcnt lgkmcnt(4)
    v_mfma_f32_32x32x16_bf16 v[160:175], v[76:79], v[212:215], v[160:175]
    buffer_load_dwordx4 v10, s[40:43], s83 offen lds
    s_waitcnt lgkmcnt(2)
    v_mfma_f32_32x32x16_bf16 v[160:175], v[80:83], v[192:195], v[160:175]
    s_add_u32 m0, s76, 16384
    s_add_u32 s83, s79, 61440
    s_waitcnt lgkmcnt(0)
    v_mfma_f32_32x32x16_bf16 v[160:175], v[84:87], v[196:199], v[160:175]
    buffer_load_dwordx4 v10, s[40:43], s83 offen lds
    ds_read_b128 v[248:251], v12
    ds_read_b128 v[252:255], v3
    s_mov_b32 s64, 0x36000000
    s_mov_b32 s65, 0x36000000
    v_pk_add_f32 v[144:145], v[144:145], v[160:161] neg_hi:[0,1]
    v_pk_add_f32 v[146:147], v[146:147], v[162:163] neg_hi:[0,1]
    v_pk_add_f32 v[148:149], v[148:149], v[164:165] neg_hi:[0,1]
    v_pk_add_f32 v[150:151], v[150:151], v[166:167] neg_hi:[0,1]
    v_pk_add_f32 v[152:153], v[152:153], v[168:169] neg_hi:[0,1]
    v_pk_add_f32 v[154:155], v[154:155], v[170:171] neg_hi:[0,1]
    v_pk_add_f32 v[156:157], v[156:157], v[172:173] neg_hi:[0,1]
    v_pk_add_f32 v[158:159], v[158:159], v[174:175] neg_hi:[0,1]
    v_pk_mul_f32 v[144:145], v[144:145], s[64:65]
    v_pk_mul_f32 v[146:147], v[146:147], s[64:65]
    v_pk_mul_f32 v[148:149], v[148:149], s[64:65]
    v_pk_mul_f32 v[150:151], v[150:151], s[64:65]
    v_pk_mul_f32 v[152:153], v[152:153], s[64:65]
    v_pk_mul_f32 v[154:155], v[154:155], s[64:65]
    v_pk_mul_f32 v[156:157], v[156:157], s[64:65]
    v_pk_mul_f32 v[158:159], v[158:159], s[64:65]
    s_waitcnt lgkmcnt(1)
    v_lshlrev_b32 v160, 16, v248
    v_and_b32 v161, 0xffff0000, v248
    v_lshlrev_b32 v162, 16, v249
    v_and_b32 v163, 0xffff0000, v249
    v_lshlrev_b32 v164, 16, v250
    v_and_b32 v165, 0xffff0000, v250
    v_lshlrev_b32 v166, 16, v251
    v_and_b32 v167, 0xffff0000, v251
    s_waitcnt lgkmcnt(0)
    v_lshlrev_b32 v168, 16, v252
    v_and_b32 v169, 0xffff0000, v252
    v_lshlrev_b32 v170, 16, v253
    v_and_b32 v171, 0xffff0000, v253
    v_lshlrev_b32 v172, 16, v254
    v_and_b32 v173, 0xffff0000, v254
    v_lshlrev_b32 v174, 16, v255
    v_and_b32 v175, 0xffff0000, v255
    s_waitcnt vmcnt(12)
    s_barrier
    ds_read_b64_tr_b16 v[192:193], v11 offset:0
    ds_read_b64_tr_b16 v[194:195], v11 offset:512
    ds_read_b64_tr_b16 v[196:197], v11 offset:2048
    ds_read_b64_tr_b16 v[198:199], v11 offset:2560
    ds_read_b64_tr_b16 v[200:201], v11 offset:4096
    ds_read_b64_tr_b16 v[202:203], v11 offset:4608
    ds_read_b64_tr_b16 v[204:205], v11 offset:6144
    ds_read_b64_tr_b16 v[206:207], v11 offset:6656
    ds_read_b64_tr_b16 v[208:209], v11 offset:8192
    ds_read_b64_tr_b16 v[210:211], v11 offset:8704
    s_add_u32 m0, s76, 20480
    s_add_u32 s83, s79, 65536
    s_waitcnt lgkmcnt(8)
    v_mfma_f32_32x32x16_bf16 v[128:143], a[0:3], v[192:195], 0
    buffer_load_dwordx4 v10, s[40:43], s83 offen lds
    ds_read_b64_tr_b16 v[212:213], v11 offset:10240
    ds_read_b64_tr_b16 v[214:215], v11 offset:10752
    s_waitcnt lgkmcnt(8)
    v_mfma_f32_32x32x16_bf16 v[128:143], a[4:7], v[196:199], v[128:143]
    ds_read_b64_tr_b16 v[192:193], v11 offset:12288
    ds_read_b64_tr_b16 v[194:195], v11 offset:12800
    s_add_u32 m0, s76, 24576
    s_add_u32 s83, s79, 69632
    s_waitcnt lgkmcnt(8)
    v_mfma_f32_32x32x16_bf16 v[128:143], a[8:11], v[200:203], v[128:143]
    buffer_load_dwordx4 v10, s[40:43], s83 offen lds
    ds_read_b64_tr_b16 v[196:197], v11 offset:14336
    ds_read_b64_tr_b16 v[198:199], v11 offset:14848
    s_add_u32 m0, s76, 28672
    s_add_u32 s83, s79, 73728
    s_waitcnt lgkmcnt(8)
    v_mfma_f32_32x32x16_bf16 v[128:143], a[12:15], v[204:207], v[128:143]
    buffer_load_dwordx4 v10, s[40:43], s83 offen lds
    s_waitcnt vmcnt(11)
    s_barrier
    ds_read_b64_tr_b16 v[200:201], v11 offset:16384
    ds_read_b64_tr_b16 v[202:203], v11 offset:16896
    s_waitcnt lgkmcnt(8)
    v_mfma_f32_32x32x16_bf16 v[128:143], a[16:19], v[208:211], v[128:143]
    ds_read_b64_tr_b16 v[204:205], v11 offset:18432
    ds_read_b64_tr_b16 v[206:207], v11 offset:18944
    s_add_u32 m0, s76, 32768
    s_add_u32 s83, s79, 77824
    s_waitcnt lgkmcnt(8)
    v_mfma_f32_32x32x16_bf16 v[128:143], a[20:23], v[212:215], v[128:143]
    buffer_load_dwordx4 v10, s[40:43], s83 offen lds
    ds_read_b64_tr_b16 v[208:209], v11 offset:20480
    ds_read_b64_tr_b16 v[210:211], v11 offset:20992
    s_add_u32 m0, s76, 36864
    s_add_u32 s83, s79, 81920
    s_waitcnt lgkmcnt(8)
    v_mfma_f32_32x32x16_bf16 v[128:143], a[24:27], v[192:195], v[128:143]
    buffer_load_dwordx4 v10, s[40:43], s83 offen lds
    ds_read_b64_tr_b16 v[212:213], v11 offset:22528
    ds_read_b64_tr_b16 v[214:215], v11 offset:23040
    s_add_u32 m0, s76, 40960
    s_add_u32 s83, s79, 86016
    s_waitcnt lgkmcnt(8)
    v_mfma_f32_32x32x16_bf16 v[128:143], a[28:31], v[196:199], v[128:143]
    buffer_load_dwordx4 v14, s[40:43], s83 offen lds
    ds_read_b64_tr_b16 v[192:193], v11 offset:24576
    ds_read_b64_tr_b16 v[194:195], v11 offset:25088
    s_waitcnt lgkmcnt(8)
    v_mfma_f32_32x32x16_bf16 v[128:143], a[32:35], v[200:203], v[128:143]
    ds_read_b64_tr_b16 v[196:197], v11 offset:26624
    ds_read_b64_tr_b16 v[198:199], v11 offset:27136
    s_waitcnt lgkmcnt(8)
    v_mfma_f32_32x32x16_bf16 v[128:143], a[36:39], v[204:207], v[128:143]
    ds_read_b64_tr_b16 v[200:201], v11 offset:28672
    ds_read_b64_tr_b16 v[202:203], v11 offset:29184
    s_waitcnt lgkmcnt(8)
    v_mfma_f32_32x32x16_bf16 v[128:143], a[40:43], v[208:211], v[128:143]
    ds_read_b64_tr_b16 v[204:205], v11 offset:30720
    ds_read_b64_tr_b16 v[206:207], v11 offset:31232
    s_waitcnt lgkmcnt(8)
    v_mfma_f32_32x32x16_bf16 v[128:143], a[44:47], v[212:215], v[128:143]
    s_waitcnt vmcnt(10)
    s_barrier
    ds_read_b64_tr_b16 v[208:209], v11 offset:32768
    ds_read_b64_tr_b16 v[210:211], v11 offset:33280
    s_waitcnt lgkmcnt(8)
    v_mfma_f32_32x32x16_bf16 v[128:143], a[48:51], v[192:195], v[128:143]
    ds_read_b64_tr_b16 v[212:213], v11 offset:34816
    ds_read_b64_tr_b16 v[214:215], v11 offset:35328
    s_waitcnt lgkmcnt(8)
    v_mfma_f32_32x32x16_bf16 v[128:143], a[52:55], v[196:199], v[128:143]
    ds_read_b64_tr_b16 v[192:193], v11 offset:36864
    ds_read_b64_tr_b16 v[194:195], v11 offset:37376
    s_waitcnt lgkmcnt(8)
    v_mfma_f32_32x32x16_bf16 v[128:143], a[56:59], v[200:203], v[128:143]
    ds_read_b64_tr_b16 v[196:197], v11 offset:38912
    ds_read_b64_tr_b16 v[198:199], v11 offset:39424
    s_waitcnt lgkmcnt(8)
    v_mfma_f32_32x32x16_bf16 v[128:143], a[60:63], v[204:207], v[128:143]
    ds_read_b64_tr_b16 v[200:201], v11 offset:40960
    ds_read_b64_tr_b16 v[202:203], v11 offset:41472
    s_waitcnt lgkmcnt(8)
    v_mfma_f32_32x32x16_bf16 v[128:143], a[64:67], v[208:211], v[128:143]
    ds_read_b64_tr_b16 v[204:205], v11 offset:43008
    ds_read_b64_tr_b16 v[206:207], v11 offset:43520
    s_waitcnt lgkmcnt(8)
    v_mfma_f32_32x32x16_bf16 v[128:143], a[68:71], v[212:215], v[128:143]
    ds_read_b64_tr_b16 v[208:209], v7 offset:0
    ds_read_b64_tr_b16 v[210:211], v7 offset:512
    s_waitcnt lgkmcnt(8)
    v_mfma_f32_32x32x16_bf16 v[128:143], a[72:75], v[192:195], v[128:143]
    ds_read_b64_tr_b16 v[212:213], v7 offset:2048
    ds_read_b64_tr_b16 v[214:215], v7 offset:2560
    s_waitcnt lgkmcnt(8)
    v_mfma_f32_32x32x16_bf16 v[128:143], a[76:79], v[196:199], v[128:143]
    s_waitcnt vmcnt(6)
    s_barrier
    ds_read_b64_tr_b16 v[192:193], v7 offset:4096
    ds_read_b64_tr_b16 v[194:195], v7 offset:4608
    s_waitcnt lgkmcnt(8)
    v_mfma_f32_32x32x16_bf16 v[128:143], a[80:83], v[200:203], v[128:143]
    ds_read_b64_tr_b16 v[196:197], v7 offset:6144
    ds_read_b64_tr_b16 v[198:199], v7 offset:6656
    s_waitcnt lgkmcnt(8)
    v_mfma_f32_32x32x16_bf16 v[128:143], a[84:87], v[204:207], v[128:143]
    ds_read_b64_tr_b16 v[200:201], v7 offset:8192
    ds_read_b64_tr_b16 v[202:203], v7 offset:8704
    s_waitcnt lgkmcnt(8)
    v_mfma_f32_32x32x16_bf16 v[128:143], a[88:91], v[208:211], v[128:143]
    ds_read_b64_tr_b16 v[204:205], v7 offset:10240
    ds_read_b64_tr_b16 v[206:207], v7 offset:10752
    s_waitcnt lgkmcnt(8)
    v_mfma_f32_32x32x16_bf16 v[128:143], a[92:95], v[212:215], v[128:143]
    ds_read_b64_tr_b16 v[208:209], v7 offset:12288
    ds_read_b64_tr_b16 v[210:211], v7 offset:12800
    s_waitcnt lgkmcnt(8)
    v_mfma_f32_32x32x16_bf16 v[128:143], a[96:99], v[192:195], v[128:143]
    ds_read_b64_tr_b16 v[212:213], v7 offset:14336
    ds_read_b64_tr_b16 v[214:215], v7 offset:14848
    s_waitcnt lgkmcnt(8)
    v_mfma_f32_32x32x16_bf16 v[128:143], a[100:103], v[196:199], v[128:143]
    ds_read_b64_tr_b16 v[192:193], v7 offset:16384
    ds_read_b64_tr_b16 v[194:195], v7 offset:16896
    s_waitcnt lgkmcnt(8)
    v_mfma_f32_32x32x16_bf16 v[128:143], a[104:107], v[200:203], v[128:143]
    ds_read_b64_tr_b16 v[196:197], v7 offset:18432
    ds_read_b64_tr_b16 v[198:199], v7 offset:18944
    s_waitcnt lgkmcnt(8)
    v_mfma_f32_32x32x16_bf16 v[128:143], a[108:111], v[204:207], v[128:143]
    s_waitcnt vmcnt(2)
    s_barrier
    ds_read_b64_tr_b16 v[200:201], v7 offset:20480
    ds_read_b64_tr_b16 v[202:203], v7 offset:20992
    s_waitcnt lgkmcnt(8)
    v_mfma_f32_32x32x16_bf16 v[128:143], a[112:115], v[208:211], v[128:143]
    ds_read_b64_tr_b16 v[204:205], v7 offset:22528
    ds_read_b64_tr_b16 v[206:207], v7 offset:23040
    s_waitcnt lgkmcnt(8)
    v_mfma_f32_32x32x16_bf16 v[128:143], a[116:119], v[212:215], v[128:143]
    ds_read_b64_tr_b16 v[208:209], v7 offset:24576
    ds_read_b64_tr_b16 v[210:211], v7 offset:25088
    s_waitcnt lgkmcnt(8)
    v_mfma_f32_32x32x16_bf16 v[128:143], a[120:123], v[192:195], v[128:143]
    ds_read_b64_tr_b16 v[212:213], v7 offset:26624
    ds_read_b64_tr_b16 v[214:215], v7 offset:27136
    s_waitcnt lgkmcnt(8)
    v_mfma_f32_32x32x16_bf16 v[128:143], a[124:127], v[196:199], v[128:143]
    ds_read_b64_tr_b16 v[192:193], v7 offset:28672
    ds_read_b64_tr_b16 v[194:195], v7 offset:29184
    s_waitcnt lgkmcnt(8)
    v_mfma_f32_32x32x16_bf16 v[128:143], a[128:131], v[200:203], v[128:143]
    ds_read_b64_tr_b16 v[196:197], v7 offset:30720
    ds_read_b64_tr_b16 v[198:199], v7 offset:31232
    s_waitcnt lgkmcnt(8)
    v_mfma_f32_32x32x16_bf16 v[128:143], a[132:135], v[204:207], v[128:143]
    ds_read_b64_tr_b16 v[200:201], v7 offset:32768
    ds_read_b64_tr_b16 v[202:203], v7 offset:33280
    s_waitcnt lgkmcnt(8)
    v_mfma_f32_32x32x16_bf16 v[128:143], a[136:139], v[208:211], v[128:143]
    ds_read_b64_tr_b16 v[204:205], v7 offset:34816
    ds_read_b64_tr_b16 v[206:207], v7 offset:35328
    s_waitcnt lgkmcnt(8)
    v_mfma_f32_32x32x16_bf16 v[128:143], a[140:143], v[212:215], v[128:143]
    s_waitcnt vmcnt(0)
    s_barrier
    ds_read_b64_tr_b16 v[208:209], v7 offset:36864
    ds_read_b64_tr_b16 v[210:211], v7 offset:37376
    s_waitcnt lgkmcnt(8)
    v_mfma_f32_32x32x16_bf16 v[128:143], a[144:147], v[192:195], v[128:143]
    ds_read_b64_tr_b16 v[212:213], v7 offset:38912
    ds_read_b64_tr_b16 v[214:215], v7 offset:39424
    s_waitcnt lgkmcnt(8)
    v_mfma_f32_32x32x16_bf16 v[128:143], a[148:151], v[196:199], v[128:143]
    ds_read_b64_tr_b16 v[192:193], v7 offset:40960
    ds_read_b64_tr_b16 v[194:195], v7 offset:41472
    s_waitcnt lgkmcnt(8)
    v_mfma_f32_32x32x16_bf16 v[128:143], a[152:155], v[200:203], v[128:143]
    s_waitcnt lgkmcnt(6)
    v_mfma_f32_32x32x16_bf16 v[128:143], a[156:159], v[204:207], v[128:143]
    s_waitcnt lgkmcnt(4)
    v_mfma_f32_32x32x16_bf16 v[128:143], a[160:163], v[208:211], v[128:143]
    s_waitcnt lgkmcnt(2)
    v_mfma_f32_32x32x16_bf16 v[128:143], a[164:167], v[212:215], v[128:143]
    s_waitcnt lgkmcnt(0)
    v_mfma_f32_32x32x16_bf16 v[128:143], a[168:171], v[192:195], v[128:143]
    s_mov_b32 s64, 0xbfb8aa3b
    s_mov_b32 s65, 0xbfb8aa3b
    s_nop 9
    v_pk_mul_f32 v[192:193], v[128:129], s[64:65]
    v_pk_mul_f32 v[194:195], v[130:131], s[64:65]
    v_pk_mul_f32 v[196:197], v[132:133], s[64:65]
    v_pk_mul_f32 v[198:199], v[134:135], s[64:65]
    v_exp_f32 v192, v192
    v_exp_f32 v193, v193
    v_exp_f32 v194, v194
    v_exp_f32 v195, v195
    v_exp_f32 v196, v196
    v_exp_f32 v197, v197
    v_exp_f32 v198, v198
    v_exp_f32 v199, v199
    v_pk_mul_f32 v[128:129], v[128:129], v[144:145]
    v_pk_mul_f32 v[130:131], v[130:131], v[146:147]
    v_pk_mul_f32 v[132:133], v[132:133], v[148:149]
    v_pk_mul_f32 v[134:135], v[134:135], v[150:151]
    v_pk_add_f32 v[192:193], v[192:193], s[66:67]
    v_pk_add_f32 v[194:195], v[194:195], s[66:67]
    v_pk_add_f32 v[196:197], v[196:197], s[66:67]
    v_pk_add_f32 v[198:199], v[198:199], s[66:67]
    v_rcp_f32 v192, v192
    v_rcp_f32 v193, v193
    v_rcp_f32 v194, v194
    v_rcp_f32 v195, v195
    v_rcp_f32 v196, v196
    v_rcp_f32 v197, v197
    v_rcp_f32 v198, v198
    v_rcp_f32 v199, v199
    s_nop 0
    v_pk_fma_f32 v[128:129], v[128:129], v[192:193], v[160:161]
    v_pk_fma_f32 v[130:131], v[130:131], v[194:195], v[162:163]
    v_pk_fma_f32 v[132:133], v[132:133], v[196:197], v[164:165]
    v_pk_fma_f32 v[134:135], v[134:135], v[198:199], v[166:167]
    v_cvt_pk_bf16_f32 v248, v128, v129
    v_cvt_pk_bf16_f32 v249, v130, v131
    v_cvt_pk_bf16_f32 v250, v132, v133
    v_cvt_pk_bf16_f32 v251, v134, v135
    ds_write_b128 v12, v[248:251]
    v_pk_mul_f32 v[200:201], v[136:137], s[64:65]
    v_pk_mul_f32 v[202:203], v[138:139], s[64:65]
    v_pk_mul_f32 v[204:205], v[140:141], s[64:65]
    v_pk_mul_f32 v[206:207], v[142:143], s[64:65]
    v_exp_f32 v200, v200
    v_exp_f32 v201, v201
    v_exp_f32 v202, v202
    v_exp_f32 v203, v203
    v_exp_f32 v204, v204
    v_exp_f32 v205, v205
    v_exp_f32 v206, v206
    v_exp_f32 v207, v207
    v_pk_mul_f32 v[136:137], v[136:137], v[152:153]
    v_pk_mul_f32 v[138:139], v[138:139], v[154:155]
    v_pk_mul_f32 v[140:141], v[140:141], v[156:157]
    v_pk_mul_f32 v[142:143], v[142:143], v[158:159]
    v_pk_add_f32 v[200:201], v[200:201], s[66:67]
    v_pk_add_f32 v[202:203], v[202:203], s[66:67]
    v_pk_add_f32 v[204:205], v[204:205], s[66:67]
    v_pk_add_f32 v[206:207], v[206:207], s[66:67]
    v_rcp_f32 v200, v200
    v_rcp_f32 v201, v201
    v_rcp_f32 v202, v202
    v_rcp_f32 v203, v203
    v_rcp_f32 v204, v204
    v_rcp_f32 v205, v205
    v_rcp_f32 v206, v206
    v_rcp_f32 v207, v207
    s_nop 0
    v_pk_fma_f32 v[136:137], v[136:137], v[200:201], v[168:169]
    v_pk_fma_f32 v[138:139], v[138:139], v[202:203], v[170:171]
    v_pk_fma_f32 v[140:141], v[140:141], v[204:205], v[172:173]
    v_pk_fma_f32 v[142:143], v[142:143], v[206:207], v[174:175]
    v_cvt_pk_bf16_f32 v252, v136, v137
    v_cvt_pk_bf16_f32 v253, v138, v139
    v_cvt_pk_bf16_f32 v254, v140, v141
    v_cvt_pk_bf16_f32 v255, v142, v143
    ds_write_b128 v3, v[252:255]
    ds_read_b128 v[192:195], v8 offset:0
    ds_read_b128 v[196:199], v8 offset:1024
    s_waitcnt lgkmcnt(1)
    buffer_store_dwordx4 v[192:195], v9, s[36:39], s74 offen
    s_waitcnt lgkmcnt(0)
    buffer_store_dwordx4 v[196:199], v9, s[36:39], s54 offen
L_end:
    s_endpgm
.section .rodata,"a"
.p2align 6
.amdhsa_kernel recurrent_scan__spectral_gfnet__mixer_gmlp__prompt_kernel
  .amdhsa_next_free_vgpr 512
  .amdhsa_next_free_sgpr 102
  .amdhsa_accum_offset 256
  .amdhsa_group_segment_fixed_size 0
  .amdhsa_kernarg_size 88
  .amdhsa_user_sgpr_count 2
  .amdhsa_user_sgpr_kernarg_segment_ptr 1
  .amdhsa_system_sgpr_workgroup_id_x 1
.end_amdhsa_kernel
```
